```python
import torch

def _softmax(x, axis=-1):
    return torch.softmax(x, dim=axis)
def _gelu(x):
    return torch.nn.functional.gelu(x, approximate="tanh")
def _silu(x):
    return torch.nn.functional.silu(x)
def _sigmoid(x):
    return torch.sigmoid(x)
def _layernorm(x, axis=-1, eps=1e-5):
    m = x.mean(dim=axis, keepdim=True)
    v = x.var(dim=axis, keepdim=True, unbiased=False)
    return (x - m) / torch.sqrt(v + eps)
def _scatter_add(tgt, idx, src, axis=0):
    return tgt.clone().index_add_(axis, idx, src)
def _segment_sum(src, seg, n):
    out = torch.zeros((n,) + src.shape[1:], dtype=src.dtype)
    return out.index_add_(0, seg, src)
def _pad(x, pw):
    flat = tuple(v for pair in reversed(pw) for v in pair)
    return torch.nn.functional.pad(x, flat)

kernel_name = 'gated_mix__linear_attn_block__glu_gated_swiglu__prompt'

def setup_inputs():

    _w = (lambda a: (lambda t: t.to(torch.bfloat16) if t.is_floating_point() else t)(torch.as_tensor(a)))
    def _A_setup():
        B, S, D = 1, 2048, 512
        return {
            "x": _w((lambda *s: torch.randn(*s, dtype=torch.bfloat16) * 0.05)(B, S, D)),
            "wqkv": _w((lambda *s: torch.randn(*s, dtype=torch.bfloat16) * 0.8)(D, 3 * D)),
            "wo": _w((lambda *s: torch.randn(*s, dtype=torch.bfloat16) * 0.05)(D, D)),
        }
    _A_in = _A_setup()

    def _B_setup():
        B, S, D, F = 1, 2048, 512, 1792
        return {
            "x": _w((lambda *s: torch.randn(*s, dtype=torch.bfloat16) * 0.05)(B, S, D)),
            "w1": _w((lambda *s: torch.randn(*s, dtype=torch.bfloat16) * 1.6)(D, F) * (2.0 / D) ** 0.5),
            "w3": _w((lambda *s: torch.randn(*s, dtype=torch.bfloat16) * 1.6)(D, F) * (2.0 / D) ** 0.5),
            "w2": _w((lambda *s: torch.randn(*s, dtype=torch.bfloat16) * 1.6)(F, D) * (2.0 / F) ** 0.5),
        }
    _B_in = _B_setup()

    return {
        "A_x": _A_in["x"],
        "A_wqkv": _A_in["wqkv"],
        "A_wo": _A_in["wo"],
        "B_x": _B_in["x"],
        "B_w1": _B_in["w1"],
        "B_w3": _B_in["w3"],
        "B_w2": _B_in["w2"],
        "gate_w": _w((lambda *s: torch.randn(*s, dtype=torch.bfloat16) * 0.05)(512) * 16.0),
    }

def reference(A_x, A_wqkv, A_wo, B_x, B_w1, B_w3, B_w2, gate_w):
    def _A_ref(x, wqkv, wo):
        B, S, D = x.shape
        H = 32; Dh = D // H
        qkv = (lambda x, *d: x.permute(*d))((x @ wqkv).reshape(B, S, 3, H, Dh), 2, 0, 3, 1, 4)
        q, k, v = qkv[0], qkv[1], qkv[2]
        phi = lambda t: torch.where(t > 0, t + 1, torch.exp(t)) + 1e-6
        pq, pk = phi(q), phi(k)
        kv = torch.einsum("bhsd,bhse->bhde", pk, v)
        z = torch.einsum("bhsd->bhd", pk)
        num = torch.einsum("bhqd,bhde->bhqe", pq, kv)
        den = torch.einsum("bhqd,bhd->bhq", pq, z)[..., None] + 1e-6
        o = num / den
        return (lambda x, *d: x.permute(*d))(o, 0, 2, 1, 3).reshape(B, S, D) @ wo

    def _B_ref(x, w1, w3, w2):
        gate = torch.einsum("bsd,df->bsf", x, w1)
        up = torch.einsum("bsd,df->bsf", x, w3)
        h = _silu(gate) * up
        out = torch.einsum("bsf,fd->bsd", h, w2)
        return out

    x = A_x
    g = _sigmoid((x * gate_w).sum(-1, keepdims=True))
    a = _A_ref(x, A_wqkv, A_wo)
    b = _B_ref(x, B_w1, B_w3, B_w2)
    return g * a + (1 - g) * b
```

```asm
; @launch kernel=k1_kernel grid=(256,1,1) block=(512,1,1) lds=155648
; @launch kernel=k2_kernel grid=(256,1,1) block=(256,1,1) lds=135168
.amdgcn_target "amdgcn-amd-amdhsa--gfx950"
.text
.globl k1_kernel
.p2align 8
.type k1_kernel,@function
k1_kernel:
    s_cmp_ge_u32 s2, 256
    s_cbranch_scc1 K1_done
    s_load_dwordx16 s[16:31], s[0:1], 0
    s_load_dwordx4 s[32:35], s[0:1], 64
    s_load_dwordx2 s[36:37], s[0:1], 80
    s_getpc_b64 s[98:99]
K1_pc:
    s_and_b32 s4, s2, 7
    s_lshr_b32 s5, s2, 3
    v_and_b32 v1, 63, v0
    v_lshrrev_b32 v12, 6, v0
    s_lshl_b32 s12, s5, 11
    v_readfirstlane_b32 s6, v12
    v_lshlrev_b32 v13, 7, v0
    v_add_u32 v13, s12, v13
    v_min_u32 v13, CODE_END-K1_pc-4, v13
    v_cmp_gt_u32 vcc, 16, v0
    s_and_saveexec_b64 s[94:95], vcc
    s_cbranch_execz K1_nopf
    global_load_dword v44, v13, s[98:99]
K1_nopf:
    s_mov_b64 exec, s[94:95]
    s_lshr_b32 s100, s6, 2
    s_and_b32 s101, s6, 3
    s_mul_i32 s12, s5, 43
    s_lshr_b32 s12, s12, 8
    s_mul_i32 s13, s12, 6
    s_sub_u32 s97, s5, s13
    s_lshl_b32 s12, s12, 3
    s_add_u32 s11, s12, s4
    s_mul_i32 s7, s97, 11
    s_max_u32 s12, s97, 4
    s_sub_u32 s12, s12, 4
    s_sub_u32 s7, s7, s12
    s_lshl_b32 s9, s11, 7
    s_mov_b32 s10, s9
    s_sub_u32 s12, s11, 28
    s_lshl_b32 s12, s12, 8
    s_add_u32 s13, s12, 128
    s_cmp_ge_u32 s11, 28
    s_cselect_b32 s9, s12, s9
    s_cselect_b32 s10, s13, s10
    s_cselect_b32 s3, 1, 0
    s_lshl_b32 s12, s4, 7
    s_add_u32 s13, s12, 2048
    s_add_u32 s12, s12, 1024
    s_sub_u32 s14, s5, 24
    s_lshl_b32 s15, s14, 3
    s_cmp_ge_u32 s5, 24
    s_cselect_b32 s9, s12, s9
    s_cselect_b32 s10, s13, s10
    s_cselect_b32 s97, s14, s97
    s_cselect_b32 s7, s15, s7
    s_cselect_b32 s3, 2, s3
    s_cmp_eq_u32 s3, 0
    s_movk_i32 s12, 3584
    s_movk_i32 s13, 3072
    s_cselect_b32 s8, s12, s13
    s_mul_i32 s14, s4, 11
    s_lshr_b32 s14, s14, 3
    s_add_u32 s7, s7, s14
    s_lshl_b32 s15, s8, 6
    s_add_u32 s91, s4, s5
    s_add_u32 s12, s91, 0
    s_and_b32 s12, s12, 7
    s_lshl_b32 s72, s12, 7
    s_mul_i32 s80, s12, s15
    s_add_u32 s12, s91, 1
    s_and_b32 s12, s12, 7
    s_lshl_b32 s73, s12, 7
    s_mul_i32 s81, s12, s15
    s_add_u32 s12, s91, 2
    s_and_b32 s12, s12, 7
    s_lshl_b32 s74, s12, 7
    s_mul_i32 s82, s12, s15
    s_add_u32 s12, s91, 3
    s_and_b32 s12, s12, 7
    s_lshl_b32 s75, s12, 7
    s_mul_i32 s83, s12, s15
    s_add_u32 s12, s91, 4
    s_and_b32 s12, s12, 7
    s_lshl_b32 s76, s12, 7
    s_mul_i32 s84, s12, s15
    s_add_u32 s12, s91, 5
    s_and_b32 s12, s12, 7
    s_lshl_b32 s77, s12, 7
    s_mul_i32 s85, s12, s15
    s_add_u32 s12, s91, 6
    s_and_b32 s12, s12, 7
    s_lshl_b32 s78, s12, 7
    s_mul_i32 s86, s12, s15
    s_add_u32 s12, s91, 7
    s_and_b32 s12, s12, 7
    s_lshl_b32 s79, s12, 7
    s_mul_i32 s87, s12, s15
    s_lshl_b32 s89, s6, 10
    s_lshl_b32 s88, s100, 12
    s_lshl_b32 s12, s101, 10
    s_add_u32 s88, s88, s12
    v_lshrrev_b32 v12, 3, v1
    v_and_b32 v13, 7, v1
    v_bfe_u32 v14, v1, 4, 1
    v_lshlrev_b32 v14, 1, v14
    v_xor_b32 v15, v13, v14
    v_xor_b32 v16, 4, v15
    s_lshl_b32 s12, s6, 3
    v_add_u32 v17, s12, v12
    v_mul_lo_u32 v17, v17, s8
    v_lshl_add_u32 v2, v15, 4, v17
    v_add_u32 v2, s9, v2
    v_lshl_add_u32 v3, v16, 4, v17
    v_add_u32 v3, s10, v3
    s_lshl_b32 s12, s101, 3
    v_add_u32 v17, s12, v12
    v_bfe_u32 v18, v17, 1, 3
    v_xor_b32 v18, v18, v13
    v_lshlrev_b32 v17, 10, v17
    v_lshl_add_u32 v4, v18, 4, v17
    s_waitcnt lgkmcnt(0)
    s_cmp_eq_u32 s3, 0
    s_cselect_b32 s44, s24, s18
    s_cselect_b32 s45, s25, s19
    s_cselect_b32 s48, s26, s18
    s_cselect_b32 s49, s27, s19
    s_lshl_b32 s46, s8, 9
    s_and_b32 s45, s45, 0xffff
    s_and_b32 s49, s49, 0xffff
    s_mov_b32 s50, s46
    s_mov_b32 s47, 0x20000
    s_mov_b32 s51, 0x20000
    s_mov_b32 s40, s16
    s_and_b32 s41, s17, 0xffff
    s_mov_b32 s42, 2097152
    s_mov_b32 s43, 0x20000
    s_add_u32 s8, s7, s100
    s_lshl_b32 s9, s8, 15
    s_lshl_b32 s10, s7, 15
    s_add_u32 m0, s89, 0
    s_nop 0
    buffer_load_dwordx4 v2, s[44:47], s80 offen lds
    s_add_u32 m0, s89, 8192
    s_nop 0
    buffer_load_dwordx4 v3, s[48:51], s80 offen lds
    s_add_u32 m0, s88, 16384
    s_add_u32 s96, s9, 0
    s_and_b32 s96, s96, 0x1fffff
    s_add_u32 s96, s96, s72
    buffer_load_dwordx4 v4, s[40:43], s96 offen lds
    s_add_u32 m0, s88, 24576
    s_add_u32 s96, s9, 65536
    s_and_b32 s96, s96, 0x1fffff
    s_add_u32 s96, s96, s72
    buffer_load_dwordx4 v4, s[40:43], s96 offen lds
    s_add_u32 m0, s89, 40960
    s_nop 0
    buffer_load_dwordx4 v2, s[44:47], s81 offen lds
    s_add_u32 m0, s89, 49152
    s_nop 0
    buffer_load_dwordx4 v3, s[48:51], s81 offen lds
    s_add_u32 m0, s88, 57344
    s_add_u32 s96, s9, 0
    s_and_b32 s96, s96, 0x1fffff
    s_add_u32 s96, s96, s73
    buffer_load_dwordx4 v4, s[40:43], s96 offen lds
    s_add_u32 m0, s88, 65536
    s_add_u32 s96, s9, 65536
    s_and_b32 s96, s96, 0x1fffff
    s_add_u32 s96, s96, s73
    buffer_load_dwordx4 v4, s[40:43], s96 offen lds
    s_add_u32 m0, s89, 81920
    s_nop 0
    buffer_load_dwordx4 v2, s[44:47], s82 offen lds
    s_add_u32 m0, s89, 90112
    s_nop 0
    buffer_load_dwordx4 v3, s[48:51], s82 offen lds
    s_add_u32 m0, s88, 98304
    s_add_u32 s96, s9, 0
    s_and_b32 s96, s96, 0x1fffff
    s_add_u32 s96, s96, s74
    buffer_load_dwordx4 v4, s[40:43], s96 offen lds
    s_add_u32 m0, s88, 106496
    s_add_u32 s96, s9, 65536
    s_and_b32 s96, s96, 0x1fffff
    s_add_u32 s96, s96, s74
    buffer_load_dwordx4 v4, s[40:43], s96 offen lds
    s_mov_b32 s52, s36
    s_and_b32 s53, s37, 0xffff
    s_mov_b32 s54, 9490432
    s_mov_b32 s55, 0x20000
    s_mov_b32 s56, s30
    s_and_b32 s57, s31, 0xffff
    s_mov_b32 s58, 1024
    s_mov_b32 s59, 0x20000
    s_mov_b32 s60, s34
    s_and_b32 s61, s35, 0xffff
    s_mov_b32 s62, 256
    s_mov_b32 s63, 0x20000
    s_mov_b32 s64, s28
    s_and_b32 s65, s29, 0xffff
    s_mov_b32 s66, 1835008
    s_mov_b32 s67, 0x20000
    s_mov_b32 s68, s20
    s_and_b32 s69, s21, 0xffff
    s_mov_b32 s70, 524288
    s_mov_b32 s71, 0x20000
    s_lshl_b32 s12, s2, 3
    s_add_u32 s12, s12, s6
    s_lshl_b32 s12, s12, 10
    v_lshlrev_b32 v45, 7, v1
    s_mov_b64 exec, 0xff
    buffer_load_dword v46, v45, s[40:43], s12 offen
    s_mov_b64 exec, -1
    s_add_u32 s12, s91, s100
    s_add_u32 s12, s12, 0
    s_and_b32 s12, s12, 7
    s_lshl_b32 s30, s12, 7
    s_add_u32 s12, s91, s100
    s_add_u32 s12, s12, 2
    s_and_b32 s12, s12, 7
    s_lshl_b32 s31, s12, 7
    s_add_u32 s12, s91, s100
    s_add_u32 s12, s12, 4
    s_and_b32 s12, s12, 7
    s_lshl_b32 s32, s12, 7
    s_add_u32 s12, s91, s100
    s_add_u32 s12, s12, 6
    s_and_b32 s12, s12, 7
    s_lshl_b32 s33, s12, 7
    s_mov_b32 s91, 0x3fb8aa3b
    s_mov_b32 s92, 0xbfb8aa3b
    s_mov_b32 s93, 0x358637bd
    v_lshlrev_b32 v6, 4, v1
    v_and_b32 v12, 31, v1
    v_lshrrev_b32 v13, 5, v1
    v_bfe_u32 v14, v12, 1, 3
    v_xor_b32 v14, v14, v13
    v_lshlrev_b32 v12, 7, v12
    s_lshl_b32 s12, s100, 12
    v_add_u32 v12, s12, v12
    v_xor_b32 v15, 0, v14
    v_lshl_add_u32 v8, v15, 4, v12
    v_xor_b32 v15, 2, v14
    v_lshl_add_u32 v9, v15, 4, v12
    v_xor_b32 v15, 4, v14
    v_lshl_add_u32 v10, v15, 4, v12
    v_xor_b32 v15, 6, v14
    v_lshl_add_u32 v11, v15, 4, v12
    v_bfe_u32 v12, v1, 4, 1
    v_lshrrev_b32 v13, 5, v1
    v_bfe_u32 v14, v1, 2, 2
    v_bfe_u32 v15, v1, 1, 1
    s_lshl_b32 s12, s101, 1
    v_add_u32 v15, s12, v15
    v_bfe_u32 v16, v1, 3, 1
    v_lshlrev_b32 v16, 1, v16
    v_lshl_add_u32 v16, v12, 2, v16
    v_xor_b32 v15, v15, v16
    v_lshlrev_b32 v17, 13, v12
    v_lshl_add_u32 v17, v13, 10, v17
    v_lshl_add_u32 v17, v14, 7, v17
    v_lshl_add_u32 v17, v15, 4, v17
    v_and_b32 v18, 1, v1
    v_lshl_add_u32 v5, v18, 3, v17
    s_cmp_eq_u32 s100, 0
    s_mov_b32 s12, 0x14000
    s_mov_b32 s13, 0x9000
    s_cselect_b32 s34, s12, s13
    s_mov_b32 s12, 0xfffe2000
    s_mov_b32 s13, 0xffff6000
    s_cselect_b32 s35, s12, s13
    s_mov_b32 s12, 0x1e000
    s_mov_b32 s13, 0xa000
    s_cselect_b32 s36, s12, s13
    s_mov_b32 s12, 0xfffe2000
    s_mov_b32 s13, 0xffff6000
    s_cselect_b32 s37, s12, s13
    s_cmp_eq_u32 s3, 2
    s_cbranch_scc1 K1_kv
    s_waitcnt vmcnt(8)
    s_barrier
    ds_read_b64_tr_b16 a[0:1], v5 offset:0
    ds_read_b64_tr_b16 a[2:3], v5 offset:512
    ds_read_b128 v[20:23], v8 offset:16384
    ds_read_b128 v[24:27], v8 offset:24576
    s_waitcnt lgkmcnt(1)
    v_mfma_f32_32x32x16_bf16 v[64:79], a[0:3], v[20:23], 0
    ds_read_b64_tr_b16 a[4:5], v5 offset:2048
    ds_read_b64_tr_b16 a[6:7], v5 offset:2560
    s_waitcnt lgkmcnt(2)
    v_mfma_f32_32x32x16_bf16 v[80:95], a[0:3], v[24:27], 0
    ds_read_b128 v[32:35], v9 offset:16384
    ds_read_b128 v[36:39], v9 offset:24576
    s_waitcnt lgkmcnt(1)
    v_mfma_f32_32x32x16_bf16 v[64:79], a[4:7], v[32:35], v[64:79]
    ds_read_b64_tr_b16 a[8:9], v5 offset:4096
    ds_read_b64_tr_b16 a[10:11], v5 offset:4608
    s_waitcnt lgkmcnt(2)
    v_mfma_f32_32x32x16_bf16 v[80:95], a[4:7], v[36:39], v[80:95]
    ds_read_b128 v[20:23], v10 offset:16384
    ds_read_b128 v[24:27], v10 offset:24576
    s_waitcnt lgkmcnt(1)
    v_mfma_f32_32x32x16_bf16 v[64:79], a[8:11], v[20:23], v[64:79]
    ds_read_b64_tr_b16 a[12:13], v5 offset:6144
    ds_read_b64_tr_b16 a[14:15], v5 offset:6656
    s_waitcnt lgkmcnt(2)
    v_mfma_f32_32x32x16_bf16 v[80:95], a[8:11], v[24:27], v[80:95]
    ds_read_b128 v[32:35], v11 offset:16384
    ds_read_b128 v[36:39], v11 offset:24576
    s_waitcnt lgkmcnt(0)
    s_waitcnt vmcnt(4)
    s_barrier
    v_add_u32 v5, 0xa000, v5
    v_add_u32 v8, 0xa000, v8
    v_add_u32 v9, 0xa000, v9
    v_add_u32 v10, 0xa000, v10
    v_add_u32 v11, 0xa000, v11
    v_mfma_f32_32x32x16_bf16 v[64:79], a[12:15], v[32:35], v[64:79]
    ds_read_b64_tr_b16 a[16:17], v5 offset:0
    ds_read_b64_tr_b16 a[18:19], v5 offset:512
    s_add_u32 m0, s89, 0
    s_nop 0
    buffer_load_dwordx4 v2, s[44:47], s83 offen lds
    v_mfma_f32_32x32x16_bf16 v[80:95], a[12:15], v[36:39], v[80:95]
    ds_read_b128 v[20:23], v8 offset:16384
    ds_read_b128 v[24:27], v8 offset:24576
    s_add_u32 m0, s89, 8192
    s_nop 0
    buffer_load_dwordx4 v3, s[48:51], s83 offen lds
    s_waitcnt lgkmcnt(1)
    v_mfma_f32_32x32x16_bf16 v[64:79], a[16:19], v[20:23], v[64:79]
    ds_read_b64_tr_b16 a[20:21], v5 offset:2048
    ds_read_b64_tr_b16 a[22:23], v5 offset:2560
    s_add_u32 m0, s88, 16384
    s_add_u32 s96, s9, 0
    s_and_b32 s96, s96, 0x1fffff
    s_add_u32 s96, s96, s75
    buffer_load_dwordx4 v4, s[40:43], s96 offen lds
    s_waitcnt lgkmcnt(2)
    v_mfma_f32_32x32x16_bf16 v[80:95], a[16:19], v[24:27], v[80:95]
    ds_read_b128 v[32:35], v9 offset:16384
    ds_read_b128 v[36:39], v9 offset:24576
    s_add_u32 m0, s88, 24576
    s_add_u32 s96, s9, 65536
    s_and_b32 s96, s96, 0x1fffff
    s_add_u32 s96, s96, s75
    buffer_load_dwordx4 v4, s[40:43], s96 offen lds
    s_waitcnt lgkmcnt(1)
    v_mfma_f32_32x32x16_bf16 v[64:79], a[20:23], v[32:35], v[64:79]
    ds_read_b64_tr_b16 a[24:25], v5 offset:4096
    ds_read_b64_tr_b16 a[26:27], v5 offset:4608
    s_waitcnt lgkmcnt(2)
    v_mfma_f32_32x32x16_bf16 v[80:95], a[20:23], v[36:39], v[80:95]
    ds_read_b128 v[20:23], v10 offset:16384
    ds_read_b128 v[24:27], v10 offset:24576
    s_waitcnt lgkmcnt(1)
    v_mfma_f32_32x32x16_bf16 v[64:79], a[24:27], v[20:23], v[64:79]
    ds_read_b64_tr_b16 a[28:29], v5 offset:6144
    ds_read_b64_tr_b16 a[30:31], v5 offset:6656
    s_waitcnt lgkmcnt(2)
    v_mfma_f32_32x32x16_bf16 v[80:95], a[24:27], v[24:27], v[80:95]
    ds_read_b128 v[32:35], v11 offset:16384
    ds_read_b128 v[36:39], v11 offset:24576
    s_waitcnt lgkmcnt(0)
    s_waitcnt vmcnt(4)
    s_barrier
    v_add_u32 v5, 0xa000, v5
    v_add_u32 v8, 0xa000, v8
    v_add_u32 v9, 0xa000, v9
    v_add_u32 v10, 0xa000, v10
    v_add_u32 v11, 0xa000, v11
    v_mfma_f32_32x32x16_bf16 v[64:79], a[28:31], v[32:35], v[64:79]
    ds_read_b64_tr_b16 a[32:33], v5 offset:0
    ds_read_b64_tr_b16 a[34:35], v5 offset:512
    s_add_u32 m0, s89, 40960
    s_nop 0
    buffer_load_dwordx4 v2, s[44:47], s84 offen lds
    v_mfma_f32_32x32x16_bf16 v[80:95], a[28:31], v[36:39], v[80:95]
    ds_read_b128 v[20:23], v8 offset:16384
    ds_read_b128 v[24:27], v8 offset:24576
    s_add_u32 m0, s89, 49152
    s_nop 0
    buffer_load_dwordx4 v3, s[48:51], s84 offen lds
    s_waitcnt lgkmcnt(1)
    v_mfma_f32_32x32x16_bf16 v[64:79], a[32:35], v[20:23], v[64:79]
    ds_read_b64_tr_b16 a[36:37], v5 offset:2048
    ds_read_b64_tr_b16 a[38:39], v5 offset:2560
    s_add_u32 m0, s88, 57344
    s_add_u32 s96, s9, 0
    s_and_b32 s96, s96, 0x1fffff
    s_add_u32 s96, s96, s76
    buffer_load_dwordx4 v4, s[40:43], s96 offen lds
    s_waitcnt lgkmcnt(2)
    v_mfma_f32_32x32x16_bf16 v[80:95], a[32:35], v[24:27], v[80:95]
    ds_read_b128 v[32:35], v9 offset:16384
    ds_read_b128 v[36:39], v9 offset:24576
    s_add_u32 m0, s88, 65536
    s_add_u32 s96, s9, 65536
    s_and_b32 s96, s96, 0x1fffff
    s_add_u32 s96, s96, s76
    buffer_load_dwordx4 v4, s[40:43], s96 offen lds
    s_waitcnt lgkmcnt(1)
    v_mfma_f32_32x32x16_bf16 v[64:79], a[36:39], v[32:35], v[64:79]
    ds_read_b64_tr_b16 a[40:41], v5 offset:4096
    ds_read_b64_tr_b16 a[42:43], v5 offset:4608
    s_waitcnt lgkmcnt(2)
    v_mfma_f32_32x32x16_bf16 v[80:95], a[36:39], v[36:39], v[80:95]
    ds_read_b128 v[20:23], v10 offset:16384
    ds_read_b128 v[24:27], v10 offset:24576
    s_waitcnt lgkmcnt(1)
    v_mfma_f32_32x32x16_bf16 v[64:79], a[40:43], v[20:23], v[64:79]
    ds_read_b64_tr_b16 a[44:45], v5 offset:6144
    ds_read_b64_tr_b16 a[46:47], v5 offset:6656
    s_waitcnt lgkmcnt(2)
    v_mfma_f32_32x32x16_bf16 v[80:95], a[40:43], v[24:27], v[80:95]
    ds_read_b128 v[32:35], v11 offset:16384
    ds_read_b128 v[36:39], v11 offset:24576
    s_waitcnt lgkmcnt(0)
    s_waitcnt vmcnt(4)
    s_barrier
    v_add_u32 v5, 0xfffec000, v5
    v_add_u32 v8, 0xfffec000, v8
    v_add_u32 v9, 0xfffec000, v9
    v_add_u32 v10, 0xfffec000, v10
    v_add_u32 v11, 0xfffec000, v11
    v_mfma_f32_32x32x16_bf16 v[64:79], a[44:47], v[32:35], v[64:79]
    ds_read_b64_tr_b16 a[48:49], v5 offset:0
    ds_read_b64_tr_b16 a[50:51], v5 offset:512
    s_add_u32 m0, s89, 81920
    s_nop 0
    buffer_load_dwordx4 v2, s[44:47], s85 offen lds
    v_mfma_f32_32x32x16_bf16 v[80:95], a[44:47], v[36:39], v[80:95]
    ds_read_b128 v[20:23], v8 offset:16384
    ds_read_b128 v[24:27], v8 offset:24576
    s_add_u32 m0, s89, 90112
    s_nop 0
    buffer_load_dwordx4 v3, s[48:51], s85 offen lds
    s_waitcnt lgkmcnt(1)
    v_mfma_f32_32x32x16_bf16 v[64:79], a[48:51], v[20:23], v[64:79]
    ds_read_b64_tr_b16 a[52:53], v5 offset:2048
    ds_read_b64_tr_b16 a[54:55], v5 offset:2560
    s_add_u32 m0, s88, 98304
    s_add_u32 s96, s9, 0
    s_and_b32 s96, s96, 0x1fffff
    s_add_u32 s96, s96, s77
    buffer_load_dwordx4 v4, s[40:43], s96 offen lds
    s_waitcnt lgkmcnt(2)
    v_mfma_f32_32x32x16_bf16 v[80:95], a[48:51], v[24:27], v[80:95]
    ds_read_b128 v[32:35], v9 offset:16384
    ds_read_b128 v[36:39], v9 offset:24576
    s_add_u32 m0, s88, 106496
    s_add_u32 s96, s9, 65536
    s_and_b32 s96, s96, 0x1fffff
    s_add_u32 s96, s96, s77
    buffer_load_dwordx4 v4, s[40:43], s96 offen lds
    s_waitcnt lgkmcnt(1)
    v_mfma_f32_32x32x16_bf16 v[64:79], a[52:55], v[32:35], v[64:79]
    ds_read_b64_tr_b16 a[56:57], v5 offset:4096
    ds_read_b64_tr_b16 a[58:59], v5 offset:4608
    s_waitcnt lgkmcnt(2)
    v_mfma_f32_32x32x16_bf16 v[80:95], a[52:55], v[36:39], v[80:95]
    ds_read_b128 v[20:23], v10 offset:16384
    ds_read_b128 v[24:27], v10 offset:24576
    s_waitcnt lgkmcnt(1)
    v_mfma_f32_32x32x16_bf16 v[64:79], a[56:59], v[20:23], v[64:79]
    ds_read_b64_tr_b16 a[60:61], v5 offset:6144
    ds_read_b64_tr_b16 a[62:63], v5 offset:6656
    s_waitcnt lgkmcnt(2)
    v_mfma_f32_32x32x16_bf16 v[80:95], a[56:59], v[24:27], v[80:95]
    ds_read_b128 v[32:35], v11 offset:16384
    ds_read_b128 v[36:39], v11 offset:24576
    s_waitcnt lgkmcnt(0)
    s_waitcnt vmcnt(4)
    s_barrier
    v_add_u32 v5, 0xa000, v5
    v_add_u32 v8, 0xa000, v8
    v_add_u32 v9, 0xa000, v9
    v_add_u32 v10, 0xa000, v10
    v_add_u32 v11, 0xa000, v11
    v_mfma_f32_32x32x16_bf16 v[64:79], a[60:63], v[32:35], v[64:79]
    ds_read_b64_tr_b16 a[64:65], v5 offset:0
    ds_read_b64_tr_b16 a[66:67], v5 offset:512
    s_add_u32 m0, s89, 0
    s_nop 0
    buffer_load_dwordx4 v2, s[44:47], s86 offen lds
    v_mfma_f32_32x32x16_bf16 v[80:95], a[60:63], v[36:39], v[80:95]
    ds_read_b128 v[20:23], v8 offset:16384
    ds_read_b128 v[24:27], v8 offset:24576
    s_add_u32 m0, s89, 8192
    s_nop 0
    buffer_load_dwordx4 v3, s[48:51], s86 offen lds
    s_waitcnt lgkmcnt(1)
    v_mfma_f32_32x32x16_bf16 v[64:79], a[64:67], v[20:23], v[64:79]
    ds_read_b64_tr_b16 a[68:69], v5 offset:2048
    ds_read_b64_tr_b16 a[70:71], v5 offset:2560
    s_add_u32 m0, s88, 16384
    s_add_u32 s96, s9, 0
    s_and_b32 s96, s96, 0x1fffff
    s_add_u32 s96, s96, s78
    buffer_load_dwordx4 v4, s[40:43], s96 offen lds
    s_waitcnt lgkmcnt(2)
    v_mfma_f32_32x32x16_bf16 v[80:95], a[64:67], v[24:27], v[80:95]
    ds_read_b128 v[32:35], v9 offset:16384
    ds_read_b128 v[36:39], v9 offset:24576
    s_add_u32 m0, s88, 24576
    s_add_u32 s96, s9, 65536
    s_and_b32 s96, s96, 0x1fffff
    s_add_u32 s96, s96, s78
    buffer_load_dwordx4 v4, s[40:43], s96 offen lds
    s_waitcnt lgkmcnt(1)
    v_mfma_f32_32x32x16_bf16 v[64:79], a[68:71], v[32:35], v[64:79]
    ds_read_b64_tr_b16 a[72:73], v5 offset:4096
    ds_read_b64_tr_b16 a[74:75], v5 offset:4608
    s_waitcnt lgkmcnt(2)
    v_mfma_f32_32x32x16_bf16 v[80:95], a[68:71], v[36:39], v[80:95]
    ds_read_b128 v[20:23], v10 offset:16384
    ds_read_b128 v[24:27], v10 offset:24576
    s_waitcnt lgkmcnt(1)
    v_mfma_f32_32x32x16_bf16 v[64:79], a[72:75], v[20:23], v[64:79]
    ds_read_b64_tr_b16 a[76:77], v5 offset:6144
    ds_read_b64_tr_b16 a[78:79], v5 offset:6656
    s_waitcnt lgkmcnt(2)
    v_mfma_f32_32x32x16_bf16 v[80:95], a[72:75], v[24:27], v[80:95]
    ds_read_b128 v[32:35], v11 offset:16384
    ds_read_b128 v[36:39], v11 offset:24576
    s_waitcnt lgkmcnt(0)
    s_waitcnt vmcnt(4)
    s_barrier
    v_add_u32 v5, 0xa000, v5
    v_add_u32 v8, 0xa000, v8
    v_add_u32 v9, 0xa000, v9
    v_add_u32 v10, 0xa000, v10
    v_add_u32 v11, 0xa000, v11
    v_mfma_f32_32x32x16_bf16 v[64:79], a[76:79], v[32:35], v[64:79]
    ds_read_b64_tr_b16 a[80:81], v5 offset:0
    ds_read_b64_tr_b16 a[82:83], v5 offset:512
    s_add_u32 m0, s89, 40960
    s_nop 0
    buffer_load_dwordx4 v2, s[44:47], s87 offen lds
    v_mfma_f32_32x32x16_bf16 v[80:95], a[76:79], v[36:39], v[80:95]
    ds_read_b128 v[20:23], v8 offset:16384
    ds_read_b128 v[24:27], v8 offset:24576
    s_add_u32 m0, s89, 49152
    s_nop 0
    buffer_load_dwordx4 v3, s[48:51], s87 offen lds
    s_waitcnt lgkmcnt(1)
    v_mfma_f32_32x32x16_bf16 v[64:79], a[80:83], v[20:23], v[64:79]
    ds_read_b64_tr_b16 a[84:85], v5 offset:2048
    ds_read_b64_tr_b16 a[86:87], v5 offset:2560
    s_add_u32 m0, s88, 57344
    s_add_u32 s96, s9, 0
    s_and_b32 s96, s96, 0x1fffff
    s_add_u32 s96, s96, s79
    buffer_load_dwordx4 v4, s[40:43], s96 offen lds
    s_waitcnt lgkmcnt(2)
    v_mfma_f32_32x32x16_bf16 v[80:95], a[80:83], v[24:27], v[80:95]
    ds_read_b128 v[32:35], v9 offset:16384
    ds_read_b128 v[36:39], v9 offset:24576
    s_add_u32 m0, s88, 65536
    s_add_u32 s96, s9, 65536
    s_and_b32 s96, s96, 0x1fffff
    s_add_u32 s96, s96, s79
    buffer_load_dwordx4 v4, s[40:43], s96 offen lds
    s_waitcnt lgkmcnt(1)
    v_mfma_f32_32x32x16_bf16 v[64:79], a[84:87], v[32:35], v[64:79]
    ds_read_b64_tr_b16 a[88:89], v5 offset:4096
    ds_read_b64_tr_b16 a[90:91], v5 offset:4608
    s_add_u32 m0, s88, 122880
    s_add_u32 s96, s10, 131072
    s_and_b32 s96, s96, 0x1fffff
    s_add_u32 s96, s96, s30
    buffer_load_dwordx4 v4, s[40:43], s96 offen lds
    s_waitcnt lgkmcnt(2)
    v_mfma_f32_32x32x16_bf16 v[80:95], a[84:87], v[36:39], v[80:95]
    ds_read_b128 v[20:23], v10 offset:16384
    ds_read_b128 v[24:27], v10 offset:24576
    s_add_u32 m0, s88, 131072
    s_add_u32 s96, s10, 131072
    s_and_b32 s96, s96, 0x1fffff
    s_add_u32 s96, s96, s31
    buffer_load_dwordx4 v4, s[40:43], s96 offen lds
    s_waitcnt lgkmcnt(1)
    v_mfma_f32_32x32x16_bf16 v[64:79], a[88:91], v[20:23], v[64:79]
    ds_read_b64_tr_b16 a[92:93], v5 offset:6144
    ds_read_b64_tr_b16 a[94:95], v5 offset:6656
    s_add_u32 m0, s88, 139264
    s_add_u32 s96, s10, 131072
    s_and_b32 s96, s96, 0x1fffff
    s_add_u32 s96, s96, s32
    buffer_load_dwordx4 v4, s[40:43], s96 offen lds
    s_waitcnt lgkmcnt(2)
    v_mfma_f32_32x32x16_bf16 v[80:95], a[88:91], v[24:27], v[80:95]
    ds_read_b128 v[32:35], v11 offset:16384
    ds_read_b128 v[36:39], v11 offset:24576
    s_add_u32 m0, s88, 147456
    s_add_u32 s96, s10, 131072
    s_and_b32 s96, s96, 0x1fffff
    s_add_u32 s96, s96, s33
    buffer_load_dwordx4 v4, s[40:43], s96 offen lds
    s_waitcnt lgkmcnt(0)
    s_waitcnt vmcnt(8)
    s_barrier
    v_add_u32 v5, 0xfffec000, v5
    v_add_u32 v8, 0xfffec000, v8
    v_add_u32 v9, 0xfffec000, v9
    v_add_u32 v10, 0xfffec000, v10
    v_add_u32 v11, 0xfffec000, v11
    v_mfma_f32_32x32x16_bf16 v[64:79], a[92:95], v[32:35], v[64:79]
    ds_read_b64_tr_b16 a[96:97], v5 offset:0
    ds_read_b64_tr_b16 a[98:99], v5 offset:512
    s_add_u32 m0, s88, 81920
    s_add_u32 s96, s10, 163840
    s_and_b32 s96, s96, 0x1fffff
    s_add_u32 s96, s96, s30
    buffer_load_dwordx4 v4, s[40:43], s96 offen lds
    v_mfma_f32_32x32x16_bf16 v[80:95], a[92:95], v[36:39], v[80:95]
    ds_read_b128 v[20:23], v8 offset:16384
    ds_read_b128 v[24:27], v8 offset:24576
    s_add_u32 m0, s88, 90112
    s_add_u32 s96, s10, 163840
    s_and_b32 s96, s96, 0x1fffff
    s_add_u32 s96, s96, s31
    buffer_load_dwordx4 v4, s[40:43], s96 offen lds
    s_waitcnt lgkmcnt(1)
    v_mfma_f32_32x32x16_bf16 v[64:79], a[96:99], v[20:23], v[64:79]
    ds_read_b64_tr_b16 a[100:101], v5 offset:2048
    ds_read_b64_tr_b16 a[102:103], v5 offset:2560
    s_add_u32 m0, s88, 98304
    s_add_u32 s96, s10, 163840
    s_and_b32 s96, s96, 0x1fffff
    s_add_u32 s96, s96, s32
    buffer_load_dwordx4 v4, s[40:43], s96 offen lds
    s_waitcnt lgkmcnt(2)
    v_mfma_f32_32x32x16_bf16 v[80:95], a[96:99], v[24:27], v[80:95]
    ds_read_b128 v[32:35], v9 offset:16384
    ds_read_b128 v[36:39], v9 offset:24576
    s_add_u32 m0, s88, 106496
    s_add_u32 s96, s10, 163840
    s_and_b32 s96, s96, 0x1fffff
    s_add_u32 s96, s96, s33
    buffer_load_dwordx4 v4, s[40:43], s96 offen lds
    s_waitcnt lgkmcnt(1)
    v_mfma_f32_32x32x16_bf16 v[64:79], a[100:103], v[32:35], v[64:79]
    ds_read_b64_tr_b16 a[104:105], v5 offset:4096
    ds_read_b64_tr_b16 a[106:107], v5 offset:4608
    s_waitcnt lgkmcnt(2)
    v_mfma_f32_32x32x16_bf16 v[80:95], a[100:103], v[36:39], v[80:95]
    ds_read_b128 v[20:23], v10 offset:16384
    ds_read_b128 v[24:27], v10 offset:24576
    s_waitcnt lgkmcnt(1)
    v_mfma_f32_32x32x16_bf16 v[64:79], a[104:107], v[20:23], v[64:79]
    ds_read_b64_tr_b16 a[108:109], v5 offset:6144
    ds_read_b64_tr_b16 a[110:111], v5 offset:6656
    s_waitcnt lgkmcnt(2)
    v_mfma_f32_32x32x16_bf16 v[80:95], a[104:107], v[24:27], v[80:95]
    ds_read_b128 v[32:35], v11 offset:16384
    ds_read_b128 v[36:39], v11 offset:24576
    s_waitcnt lgkmcnt(0)
    s_waitcnt vmcnt(8)
    s_barrier
    v_add_u32 v5, 0xa000, v5
    v_add_u32 v8, 0xa000, v8
    v_add_u32 v9, 0xa000, v9
    v_add_u32 v10, 0xa000, v10
    v_add_u32 v11, 0xa000, v11
    v_mfma_f32_32x32x16_bf16 v[64:79], a[108:111], v[32:35], v[64:79]
    ds_read_b64_tr_b16 a[112:113], v5 offset:0
    ds_read_b64_tr_b16 a[114:115], v5 offset:512
    s_add_u32 m0, s88, 0
    s_add_u32 s96, s10, 196608
    s_and_b32 s96, s96, 0x1fffff
    s_add_u32 s96, s96, s30
    buffer_load_dwordx4 v4, s[40:43], s96 offen lds
    v_mfma_f32_32x32x16_bf16 v[80:95], a[108:111], v[36:39], v[80:95]
    ds_read_b128 v[20:23], v8 offset:16384
    ds_read_b128 v[24:27], v8 offset:24576
    s_add_u32 m0, s88, 8192
    s_add_u32 s96, s10, 196608
    s_and_b32 s96, s96, 0x1fffff
    s_add_u32 s96, s96, s31
    buffer_load_dwordx4 v4, s[40:43], s96 offen lds
    s_waitcnt lgkmcnt(1)
    v_mfma_f32_32x32x16_bf16 v[64:79], a[112:115], v[20:23], v[64:79]
    ds_read_b64_tr_b16 a[116:117], v5 offset:2048
    ds_read_b64_tr_b16 a[118:119], v5 offset:2560
    s_add_u32 m0, s88, 16384
    s_add_u32 s96, s10, 196608
    s_and_b32 s96, s96, 0x1fffff
    s_add_u32 s96, s96, s32
    buffer_load_dwordx4 v4, s[40:43], s96 offen lds
    s_waitcnt lgkmcnt(2)
    v_mfma_f32_32x32x16_bf16 v[80:95], a[112:115], v[24:27], v[80:95]
    ds_read_b128 v[32:35], v9 offset:16384
    ds_read_b128 v[36:39], v9 offset:24576
    s_add_u32 m0, s88, 24576
    s_add_u32 s96, s10, 196608
    s_and_b32 s96, s96, 0x1fffff
    s_add_u32 s96, s96, s33
    buffer_load_dwordx4 v4, s[40:43], s96 offen lds
    s_waitcnt lgkmcnt(1)
    v_mfma_f32_32x32x16_bf16 v[64:79], a[116:119], v[32:35], v[64:79]
    ds_read_b64_tr_b16 a[120:121], v5 offset:4096
    ds_read_b64_tr_b16 a[122:123], v5 offset:4608
    s_waitcnt lgkmcnt(2)
    v_mfma_f32_32x32x16_bf16 v[80:95], a[116:119], v[36:39], v[80:95]
    ds_read_b128 v[20:23], v10 offset:16384
    ds_read_b128 v[24:27], v10 offset:24576
    s_waitcnt lgkmcnt(1)
    v_mfma_f32_32x32x16_bf16 v[64:79], a[120:123], v[20:23], v[64:79]
    ds_read_b64_tr_b16 a[124:125], v5 offset:6144
    ds_read_b64_tr_b16 a[126:127], v5 offset:6656
    s_waitcnt lgkmcnt(2)
    v_mfma_f32_32x32x16_bf16 v[80:95], a[120:123], v[24:27], v[80:95]
    ds_read_b128 v[32:35], v11 offset:16384
    ds_read_b128 v[36:39], v11 offset:24576
    s_waitcnt lgkmcnt(0)
    s_waitcnt vmcnt(4)
    s_barrier
    v_add_u32 v8, s34, v8
    v_add_u32 v9, s34, v9
    v_add_u32 v10, s34, v10
    v_add_u32 v11, s34, v11
    v_mfma_f32_32x32x16_bf16 v[64:79], a[124:127], v[32:35], v[64:79]
    ds_read_b128 v[20:23], v8 offset:0
    ds_read_b128 v[24:27], v9 offset:0
    s_add_u32 m0, s88, 40960
    s_add_u32 s96, s10, 229376
    s_and_b32 s96, s96, 0x1fffff
    s_add_u32 s96, s96, s30
    buffer_load_dwordx4 v4, s[40:43], s96 offen lds
    v_mfma_f32_32x32x16_bf16 v[80:95], a[124:127], v[36:39], v[80:95]
    ds_read_b128 v[28:31], v10 offset:0
    s_add_u32 m0, s88, 49152
    s_add_u32 s96, s10, 229376
    s_and_b32 s96, s96, 0x1fffff
    s_add_u32 s96, s96, s31
    buffer_load_dwordx4 v4, s[40:43], s96 offen lds
    s_cmp_eq_u32 s3, 1
    s_cbranch_scc1 K1_q
    s_lshl_b32 s12, s11, 2
    s_add_u32 s12, s12, s101
    s_lshl_b32 s90, s12, 10
    ds_read_b128 v[32:35], v11 offset:0
    ds_read_b128 v[36:39], v8 offset:4096
    s_waitcnt lgkmcnt(4)
    v_mfma_f32_32x32x16_bf16 v[96:111], a[0:3], v[20:23], 0
    ds_read_b128 v[40:43], v9 offset:4096
    s_add_u32 m0, s88, 57344
    s_add_u32 s96, s10, 229376
    s_and_b32 s96, s96, 0x1fffff
    s_add_u32 s96, s96, s32
    buffer_load_dwordx4 v4, s[40:43], s96 offen lds
    v_mul_f32 v72, v64, v72
    v_mul_f32 v73, v65, v73
    v_mul_f32 v74, v66, v74
    s_waitcnt lgkmcnt(4)
    v_mfma_f32_32x32x16_bf16 v[96:111], a[4:7], v[24:27], v[96:111]
    ds_read_b128 v[20:23], v10 offset:4096
    s_add_u32 m0, s88, 65536
    s_add_u32 s96, s10, 229376
    s_and_b32 s96, s96, 0x1fffff
    s_add_u32 s96, s96, s33
    buffer_load_dwordx4 v4, s[40:43], s96 offen lds
    v_mul_f32 v75, v67, v75
    v_mul_f32 v76, v68, v76
    v_mul_f32 v77, v69, v77
    s_waitcnt lgkmcnt(4)
    v_mfma_f32_32x32x16_bf16 v[96:111], a[8:11], v[28:31], v[96:111]
    ds_read_b128 v[24:27], v11 offset:4096
    v_mul_f32 v78, v70, v78
    v_mul_f32 v79, v71, v79
    v_mul_f32 v64, s92, v64
    v_mul_f32 v65, s92, v65
    v_mul_f32 v66, s92, v66
    v_mul_f32 v67, s92, v67
    v_mul_f32 v68, s92, v68
    s_waitcnt lgkmcnt(4)
    v_mfma_f32_32x32x16_bf16 v[96:111], a[12:15], v[32:35], v[96:111]
    ds_read_b128 v[28:31], v8 offset:8192
    v_mul_f32 v69, s92, v69
    v_mul_f32 v70, s92, v70
    v_mul_f32 v71, s92, v71
    v_exp_f32 v64, v64
    v_exp_f32 v65, v65
    s_waitcnt lgkmcnt(4)
    v_mfma_f32_32x32x16_bf16 v[96:111], a[16:19], v[36:39], v[96:111]
    ds_read_b128 v[32:35], v9 offset:8192
    v_exp_f32 v66, v66
    v_exp_f32 v67, v67
    v_exp_f32 v68, v68
    s_waitcnt lgkmcnt(4)
    v_mfma_f32_32x32x16_bf16 v[96:111], a[20:23], v[40:43], v[96:111]
    ds_read_b128 v[36:39], v10 offset:8192
    v_exp_f32 v69, v69
    v_exp_f32 v70, v70
    v_exp_f32 v71, v71
    v_add_f32 v64, 1.0, v64
    s_waitcnt lgkmcnt(4)
    v_mfma_f32_32x32x16_bf16 v[96:111], a[24:27], v[20:23], v[96:111]
    ds_read_b128 v[40:43], v11 offset:8192
    v_add_f32 v65, 1.0, v65
    v_add_f32 v66, 1.0, v66
    v_add_f32 v67, 1.0, v67
    v_add_f32 v68, 1.0, v68
    v_add_f32 v69, 1.0, v69
    v_add_f32 v70, 1.0, v70
    v_add_f32 v71, 1.0, v71
    s_waitcnt lgkmcnt(4)
    v_mfma_f32_32x32x16_bf16 v[96:111], a[28:31], v[24:27], v[96:111]
    ds_read_b128 v[20:23], v8 offset:12288
    v_rcp_f32 v64, v64
    v_rcp_f32 v65, v65
    v_rcp_f32 v66, v66
    s_waitcnt lgkmcnt(4)
    v_mfma_f32_32x32x16_bf16 v[96:111], a[32:35], v[28:31], v[96:111]
    ds_read_b128 v[24:27], v9 offset:12288
    v_rcp_f32 v67, v67
    v_rcp_f32 v68, v68
    v_rcp_f32 v69, v69
    s_waitcnt lgkmcnt(4)
    v_mfma_f32_32x32x16_bf16 v[96:111], a[36:39], v[32:35], v[96:111]
    ds_read_b128 v[28:31], v10 offset:12288
    v_rcp_f32 v70, v70
    v_rcp_f32 v71, v71
    v_mul_f32 v72, v64, v72
    v_mul_f32 v73, v65, v73
    v_mul_f32 v74, v66, v74
    s_waitcnt lgkmcnt(4)
    v_mfma_f32_32x32x16_bf16 v[96:111], a[40:43], v[36:39], v[96:111]
    ds_read_b128 v[32:35], v11 offset:12288
    v_mul_f32 v75, v67, v75
    v_mul_f32 v76, v68, v76
    v_mul_f32 v77, v69, v77
    v_mul_f32 v78, v70, v78
    v_mul_f32 v79, v71, v79
    v_cvt_pk_bf16_f32 v64, v72, v73
    v_cvt_pk_bf16_f32 v65, v74, v75
    s_waitcnt lgkmcnt(4)
    v_mfma_f32_32x32x16_bf16 v[96:111], a[44:47], v[40:43], v[96:111]
    ds_read_b128 v[36:39], v8 offset:16384
    v_cvt_pk_bf16_f32 v66, v76, v77
    v_cvt_pk_bf16_f32 v67, v78, v79
    s_add_u32 s96, s8, 0
    s_and_b32 s96, s96, 63
    s_mul_i32 s96, s96, 147456
    s_add_u32 s96, s96, s90
    buffer_store_dwordx4 v[64:67], v6, s[52:55], s96 offen sc1
    s_nop 0
    v_mul_f32 v88, v80, v88
    v_mul_f32 v89, v81, v89
    s_waitcnt lgkmcnt(4)
    v_mfma_f32_32x32x16_bf16 v[96:111], a[48:51], v[20:23], v[96:111]
    ds_read_b128 v[40:43], v9 offset:16384
    v_mul_f32 v90, v82, v90
    v_mul_f32 v91, v83, v91
    v_mul_f32 v92, v84, v92
    v_mul_f32 v93, v85, v93
    v_mul_f32 v94, v86, v94
    v_mul_f32 v95, v87, v95
    v_mul_f32 v80, s92, v80
    s_waitcnt lgkmcnt(4)
    v_mfma_f32_32x32x16_bf16 v[96:111], a[52:55], v[24:27], v[96:111]
    ds_read_b128 v[20:23], v10 offset:16384
    v_mul_f32 v81, s92, v81
    v_mul_f32 v82, s92, v82
    v_mul_f32 v83, s92, v83
    v_mul_f32 v84, s92, v84
    v_mul_f32 v85, s92, v85
    v_mul_f32 v86, s92, v86
    v_mul_f32 v87, s92, v87
    s_waitcnt lgkmcnt(4)
    v_mfma_f32_32x32x16_bf16 v[96:111], a[56:59], v[28:31], v[96:111]
    ds_read_b128 v[24:27], v11 offset:16384
    v_exp_f32 v80, v80
    v_exp_f32 v81, v81
    v_exp_f32 v82, v82
    s_waitcnt lgkmcnt(4)
    v_mfma_f32_32x32x16_bf16 v[96:111], a[60:63], v[32:35], v[96:111]
    ds_read_b128 v[28:31], v8 offset:20480
    v_exp_f32 v83, v83
    v_exp_f32 v84, v84
    v_exp_f32 v85, v85
    s_waitcnt lgkmcnt(4)
    v_mfma_f32_32x32x16_bf16 v[96:111], a[64:67], v[36:39], v[96:111]
    ds_read_b128 v[32:35], v9 offset:20480
    v_exp_f32 v86, v86
    v_exp_f32 v87, v87
    v_add_f32 v80, 1.0, v80
    v_add_f32 v81, 1.0, v81
    v_add_f32 v82, 1.0, v82
    s_waitcnt lgkmcnt(4)
    v_mfma_f32_32x32x16_bf16 v[96:111], a[68:71], v[40:43], v[96:111]
    ds_read_b128 v[36:39], v10 offset:20480
    v_add_f32 v83, 1.0, v83
    v_add_f32 v84, 1.0, v84
    v_add_f32 v85, 1.0, v85
    v_add_f32 v86, 1.0, v86
    v_add_f32 v87, 1.0, v87
    v_rcp_f32 v80, v80
    s_waitcnt lgkmcnt(4)
    v_mfma_f32_32x32x16_bf16 v[96:111], a[72:75], v[20:23], v[96:111]
    ds_read_b128 v[40:43], v11 offset:20480
    v_rcp_f32 v81, v81
    v_rcp_f32 v82, v82
    v_rcp_f32 v83, v83
    s_waitcnt lgkmcnt(4)
    v_mfma_f32_32x32x16_bf16 v[96:111], a[76:79], v[24:27], v[96:111]
    ds_read_b128 v[20:23], v8 offset:24576
    v_rcp_f32 v84, v84
    v_rcp_f32 v85, v85
    v_rcp_f32 v86, v86
    s_waitcnt lgkmcnt(4)
    v_mfma_f32_32x32x16_bf16 v[96:111], a[80:83], v[28:31], v[96:111]
    ds_read_b128 v[24:27], v9 offset:24576
    v_rcp_f32 v87, v87
    v_mul_f32 v88, v80, v88
    v_mul_f32 v89, v81, v89
    v_mul_f32 v90, v82, v90
    v_mul_f32 v91, v83, v91
    v_mul_f32 v92, v84, v92
    s_waitcnt lgkmcnt(4)
    v_mfma_f32_32x32x16_bf16 v[96:111], a[84:87], v[32:35], v[96:111]
    ds_read_b128 v[28:31], v10 offset:24576
    v_mul_f32 v93, v85, v93
    v_mul_f32 v94, v86, v94
    v_mul_f32 v95, v87, v95
    v_cvt_pk_bf16_f32 v80, v88, v89
    v_cvt_pk_bf16_f32 v81, v90, v91
    v_cvt_pk_bf16_f32 v82, v92, v93
    v_cvt_pk_bf16_f32 v83, v94, v95
    s_waitcnt lgkmcnt(4)
    v_mfma_f32_32x32x16_bf16 v[96:111], a[88:91], v[36:39], v[96:111]
    ds_read_b128 v[32:35], v11 offset:24576
    s_add_u32 s96, s8, 2
    s_and_b32 s96, s96, 63
    s_mul_i32 s96, s96, 147456
    s_add_u32 s96, s96, s90
    buffer_store_dwordx4 v[80:83], v6, s[52:55], s96 offen sc1
    s_nop 0
    s_waitcnt lgkmcnt(4)
    v_mfma_f32_32x32x16_bf16 v[96:111], a[92:95], v[40:43], v[96:111]
    ds_read_b128 v[36:39], v8 offset:28672
    s_waitcnt lgkmcnt(4)
    v_mfma_f32_32x32x16_bf16 v[96:111], a[96:99], v[20:23], v[96:111]
    ds_read_b128 v[40:43], v9 offset:28672
    s_waitcnt lgkmcnt(4)
    v_mfma_f32_32x32x16_bf16 v[96:111], a[100:103], v[24:27], v[96:111]
    ds_read_b128 v[20:23], v10 offset:28672
    s_waitcnt lgkmcnt(4)
    v_mfma_f32_32x32x16_bf16 v[96:111], a[104:107], v[28:31], v[96:111]
    ds_read_b128 v[24:27], v11 offset:28672
    s_waitcnt vmcnt(2) lgkmcnt(0)
    s_barrier
    v_add_u32 v8, s35, v8
    v_add_u32 v9, s35, v9
    v_add_u32 v10, s35, v10
    v_add_u32 v11, s35, v11
    v_mfma_f32_32x32x16_bf16 v[96:111], a[108:111], v[32:35], v[96:111]
    ds_read_b128 v[28:31], v8 offset:0
    s_add_u32 m0, s88, 122880
    s_add_u32 s96, s10, 262144
    s_and_b32 s96, s96, 0x1fffff
    s_add_u32 s96, s96, s30
    buffer_load_dwordx4 v4, s[40:43], s96 offen lds
    v_mfma_f32_32x32x16_bf16 v[96:111], a[112:115], v[36:39], v[96:111]
    ds_read_b128 v[32:35], v9 offset:0
    s_add_u32 m0, s88, 131072
    s_add_u32 s96, s10, 262144
    s_and_b32 s96, s96, 0x1fffff
    s_add_u32 s96, s96, s31
    buffer_load_dwordx4 v4, s[40:43], s96 offen lds
    v_mfma_f32_32x32x16_bf16 v[96:111], a[116:119], v[40:43], v[96:111]
    ds_read_b128 v[36:39], v10 offset:0
    s_add_u32 m0, s88, 139264
    s_add_u32 s96, s10, 262144
    s_and_b32 s96, s96, 0x1fffff
    s_add_u32 s96, s96, s32
    buffer_load_dwordx4 v4, s[40:43], s96 offen lds
    v_mfma_f32_32x32x16_bf16 v[96:111], a[120:123], v[20:23], v[96:111]
    ds_read_b128 v[40:43], v11 offset:0
    s_add_u32 m0, s88, 147456
    s_add_u32 s96, s10, 262144
    s_and_b32 s96, s96, 0x1fffff
    s_add_u32 s96, s96, s33
    buffer_load_dwordx4 v4, s[40:43], s96 offen lds
    v_mfma_f32_32x32x16_bf16 v[96:111], a[124:127], v[24:27], v[96:111]
    ds_read_b128 v[20:23], v8 offset:4096
    s_add_u32 m0, s88, 81920
    s_add_u32 s96, s10, 294912
    s_and_b32 s96, s96, 0x1fffff
    s_add_u32 s96, s96, s30
    buffer_load_dwordx4 v4, s[40:43], s96 offen lds
    s_waitcnt lgkmcnt(4)
    v_mfma_f32_32x32x16_bf16 v[112:127], a[0:3], v[28:31], 0
    ds_read_b128 v[24:27], v9 offset:4096
    s_add_u32 m0, s88, 90112
    s_add_u32 s96, s10, 294912
    s_and_b32 s96, s96, 0x1fffff
    s_add_u32 s96, s96, s31
    buffer_load_dwordx4 v4, s[40:43], s96 offen lds
    v_mul_f32 v104, v96, v104
    v_mul_f32 v105, v97, v105
    v_mul_f32 v106, v98, v106
    s_waitcnt lgkmcnt(4)
    v_mfma_f32_32x32x16_bf16 v[112:127], a[4:7], v[32:35], v[112:127]
    ds_read_b128 v[28:31], v10 offset:4096
    s_add_u32 m0, s88, 98304
    s_add_u32 s96, s10, 294912
    s_and_b32 s96, s96, 0x1fffff
    s_add_u32 s96, s96, s32
    buffer_load_dwordx4 v4, s[40:43], s96 offen lds
    v_mul_f32 v107, v99, v107
    v_mul_f32 v108, v100, v108
    v_mul_f32 v109, v101, v109
    s_waitcnt lgkmcnt(4)
    v_mfma_f32_32x32x16_bf16 v[112:127], a[8:11], v[36:39], v[112:127]
    ds_read_b128 v[32:35], v11 offset:4096
    s_add_u32 m0, s88, 106496
    s_add_u32 s96, s10, 294912
    s_and_b32 s96, s96, 0x1fffff
    s_add_u32 s96, s96, s33
    buffer_load_dwordx4 v4, s[40:43], s96 offen lds
    v_mul_f32 v110, v102, v110
    v_mul_f32 v111, v103, v111
    v_mul_f32 v96, s92, v96
    s_waitcnt lgkmcnt(4)
    v_mfma_f32_32x32x16_bf16 v[112:127], a[12:15], v[40:43], v[112:127]
    ds_read_b128 v[36:39], v8 offset:8192
    v_mul_f32 v97, s92, v97
    v_mul_f32 v98, s92, v98
    v_mul_f32 v99, s92, v99
    v_mul_f32 v100, s92, v100
    v_mul_f32 v101, s92, v101
    v_mul_f32 v102, s92, v102
    v_mul_f32 v103, s92, v103
    s_waitcnt lgkmcnt(4)
    v_mfma_f32_32x32x16_bf16 v[112:127], a[16:19], v[20:23], v[112:127]
    ds_read_b128 v[40:43], v9 offset:8192
    s_lshl_b32 s12, s5, 3
    s_add_u32 s12, s12, s6
    s_mul_i32 s12, s12, 12288
    s_and_b32 s13, s4, 1
    s_lshl_b32 s13, s13, 9
    s_add_u32 s12, s12, s13
    v_lshrrev_b32 v45, 2, v1
    v_lshlrev_b32 v45, 10, v45
    v_and_b32 v46, 3, v1
    v_lshl_add_u32 v45, v46, 7, v45
    v_add_u32 v45, s12, v45
    v_subrev_u32 v46, 1835008, v45
    s_mov_b32 exec_hi, 0xffff
    buffer_load_dword v44, v45, s[64:67], 0 offen
    buffer_load_dword v44, v46, s[68:71], 0 offen
    s_mov_b64 exec, -1
    v_exp_f32 v96, v96
    s_waitcnt lgkmcnt(4)
    v_mfma_f32_32x32x16_bf16 v[112:127], a[20:23], v[24:27], v[112:127]
    ds_read_b128 v[20:23], v10 offset:8192
    v_exp_f32 v97, v97
    v_exp_f32 v98, v98
    v_exp_f32 v99, v99
    s_waitcnt lgkmcnt(4)
    v_mfma_f32_32x32x16_bf16 v[112:127], a[24:27], v[28:31], v[112:127]
    ds_read_b128 v[24:27], v11 offset:8192
    v_exp_f32 v100, v100
    v_exp_f32 v101, v101
    v_exp_f32 v102, v102
    s_waitcnt lgkmcnt(4)
    v_mfma_f32_32x32x16_bf16 v[112:127], a[28:31], v[32:35], v[112:127]
    ds_read_b128 v[28:31], v8 offset:12288
    v_exp_f32 v103, v103
    v_add_f32 v96, 1.0, v96
    v_add_f32 v97, 1.0, v97
    v_add_f32 v98, 1.0, v98
    v_add_f32 v99, 1.0, v99
    v_add_f32 v100, 1.0, v100
    s_waitcnt lgkmcnt(4)
    v_mfma_f32_32x32x16_bf16 v[112:127], a[32:35], v[36:39], v[112:127]
    ds_read_b128 v[32:35], v9 offset:12288
    v_add_f32 v101, 1.0, v101
    v_add_f32 v102, 1.0, v102
    v_add_f32 v103, 1.0, v103
    v_rcp_f32 v96, v96
    v_rcp_f32 v97, v97
    s_waitcnt lgkmcnt(4)
    v_mfma_f32_32x32x16_bf16 v[112:127], a[36:39], v[40:43], v[112:127]
    ds_read_b128 v[36:39], v10 offset:12288
    v_rcp_f32 v98, v98
    v_rcp_f32 v99, v99
    v_rcp_f32 v100, v100
    s_waitcnt lgkmcnt(4)
    v_mfma_f32_32x32x16_bf16 v[112:127], a[40:43], v[20:23], v[112:127]
    ds_read_b128 v[40:43], v11 offset:12288
    v_rcp_f32 v101, v101
    v_rcp_f32 v102, v102
    v_rcp_f32 v103, v103
    v_mul_f32 v104, v96, v104
    s_waitcnt lgkmcnt(4)
    v_mfma_f32_32x32x16_bf16 v[112:127], a[44:47], v[24:27], v[112:127]
    ds_read_b128 v[20:23], v8 offset:16384
    v_mul_f32 v105, v97, v105
    v_mul_f32 v106, v98, v106
    v_mul_f32 v107, v99, v107
    v_mul_f32 v108, v100, v108
    v_mul_f32 v109, v101, v109
    v_mul_f32 v110, v102, v110
    v_mul_f32 v111, v103, v111
    s_waitcnt lgkmcnt(4)
    v_mfma_f32_32x32x16_bf16 v[112:127], a[48:51], v[28:31], v[112:127]
    ds_read_b128 v[24:27], v9 offset:16384
    v_cvt_pk_bf16_f32 v96, v104, v105
    v_cvt_pk_bf16_f32 v97, v106, v107
    v_cvt_pk_bf16_f32 v98, v108, v109
    v_cvt_pk_bf16_f32 v99, v110, v111
    s_add_u32 s96, s8, 4
    s_and_b32 s96, s96, 63
    s_mul_i32 s96, s96, 147456
    s_add_u32 s96, s96, s90
    buffer_store_dwordx4 v[96:99], v6, s[52:55], s96 offen sc1
    s_nop 0
    s_waitcnt lgkmcnt(4)
    v_mfma_f32_32x32x16_bf16 v[112:127], a[52:55], v[32:35], v[112:127]
    ds_read_b128 v[28:31], v10 offset:16384
    s_waitcnt lgkmcnt(4)
    v_mfma_f32_32x32x16_bf16 v[112:127], a[56:59], v[36:39], v[112:127]
    ds_read_b128 v[32:35], v11 offset:16384
    s_waitcnt lgkmcnt(4)
    v_mfma_f32_32x32x16_bf16 v[112:127], a[60:63], v[40:43], v[112:127]
    ds_read_b128 v[36:39], v8 offset:20480
    s_waitcnt lgkmcnt(4)
    v_mfma_f32_32x32x16_bf16 v[112:127], a[64:67], v[20:23], v[112:127]
    ds_read_b128 v[40:43], v9 offset:20480
    s_waitcnt lgkmcnt(4)
    v_mfma_f32_32x32x16_bf16 v[112:127], a[68:71], v[24:27], v[112:127]
    ds_read_b128 v[20:23], v10 offset:20480
    s_waitcnt lgkmcnt(4)
    v_mfma_f32_32x32x16_bf16 v[112:127], a[72:75], v[28:31], v[112:127]
    ds_read_b128 v[24:27], v11 offset:20480
    s_waitcnt lgkmcnt(4)
    v_mfma_f32_32x32x16_bf16 v[112:127], a[76:79], v[32:35], v[112:127]
    ds_read_b128 v[28:31], v8 offset:24576
    s_waitcnt lgkmcnt(4)
    v_mfma_f32_32x32x16_bf16 v[112:127], a[80:83], v[36:39], v[112:127]
    ds_read_b128 v[32:35], v9 offset:24576
    s_waitcnt lgkmcnt(4)
    v_mfma_f32_32x32x16_bf16 v[112:127], a[84:87], v[40:43], v[112:127]
    ds_read_b128 v[36:39], v10 offset:24576
    s_waitcnt lgkmcnt(4)
    v_mfma_f32_32x32x16_bf16 v[112:127], a[88:91], v[20:23], v[112:127]
    ds_read_b128 v[40:43], v11 offset:24576
    s_waitcnt lgkmcnt(4)
    v_mfma_f32_32x32x16_bf16 v[112:127], a[92:95], v[24:27], v[112:127]
    ds_read_b128 v[20:23], v8 offset:28672
    s_waitcnt lgkmcnt(4)
    v_mfma_f32_32x32x16_bf16 v[112:127], a[96:99], v[28:31], v[112:127]
    ds_read_b128 v[24:27], v9 offset:28672
    s_waitcnt lgkmcnt(4)
    v_mfma_f32_32x32x16_bf16 v[112:127], a[100:103], v[32:35], v[112:127]
    ds_read_b128 v[28:31], v10 offset:28672
    s_waitcnt lgkmcnt(4)
    v_mfma_f32_32x32x16_bf16 v[112:127], a[104:107], v[36:39], v[112:127]
    ds_read_b128 v[32:35], v11 offset:28672
    s_waitcnt vmcnt(3) lgkmcnt(0)
    s_barrier
    v_add_u32 v8, s36, v8
    v_add_u32 v9, s36, v9
    v_add_u32 v10, s36, v10
    v_add_u32 v11, s36, v11
    v_mfma_f32_32x32x16_bf16 v[112:127], a[108:111], v[40:43], v[112:127]
    ds_read_b128 v[36:39], v8 offset:0
    s_add_u32 m0, s88, 0
    s_add_u32 s96, s10, 327680
    s_and_b32 s96, s96, 0x1fffff
    s_add_u32 s96, s96, s30
    buffer_load_dwordx4 v4, s[40:43], s96 offen lds
    v_mfma_f32_32x32x16_bf16 v[112:127], a[112:115], v[20:23], v[112:127]
    ds_read_b128 v[40:43], v9 offset:0
    s_add_u32 m0, s88, 8192
    s_add_u32 s96, s10, 327680
    s_and_b32 s96, s96, 0x1fffff
    s_add_u32 s96, s96, s31
    buffer_load_dwordx4 v4, s[40:43], s96 offen lds
    v_mfma_f32_32x32x16_bf16 v[112:127], a[116:119], v[24:27], v[112:127]
    ds_read_b128 v[20:23], v10 offset:0
    s_add_u32 m0, s88, 16384
    s_add_u32 s96, s10, 327680
    s_and_b32 s96, s96, 0x1fffff
    s_add_u32 s96, s96, s32
    buffer_load_dwordx4 v4, s[40:43], s96 offen lds
    v_mfma_f32_32x32x16_bf16 v[112:127], a[120:123], v[28:31], v[112:127]
    ds_read_b128 v[24:27], v11 offset:0
    s_add_u32 m0, s88, 24576
    s_add_u32 s96, s10, 327680
    s_and_b32 s96, s96, 0x1fffff
    s_add_u32 s96, s96, s33
    buffer_load_dwordx4 v4, s[40:43], s96 offen lds
    v_mfma_f32_32x32x16_bf16 v[112:127], a[124:127], v[32:35], v[112:127]
    ds_read_b128 v[28:31], v8 offset:4096
    s_waitcnt lgkmcnt(4)
    v_mfma_f32_32x32x16_bf16 v[64:79], a[0:3], v[36:39], 0
    ds_read_b128 v[32:35], v9 offset:4096
    s_nop 8
    v_mul_f32 v120, v112, v120
    v_mul_f32 v121, v113, v121
    v_mul_f32 v122, v114, v122
    v_mul_f32 v123, v115, v123
    v_mul_f32 v124, v116, v124
    v_mul_f32 v125, v117, v125
    v_mul_f32 v126, v118, v126
    s_waitcnt lgkmcnt(4)
    v_mfma_f32_32x32x16_bf16 v[64:79], a[4:7], v[40:43], v[64:79]
    ds_read_b128 v[36:39], v10 offset:4096
    v_mul_f32 v127, v119, v127
    v_mul_f32 v112, s92, v112
    v_mul_f32 v113, s92, v113
    v_mul_f32 v114, s92, v114
    v_mul_f32 v115, s92, v115
    v_mul_f32 v116, s92, v116
    v_mul_f32 v117, s92, v117
    s_waitcnt lgkmcnt(4)
    v_mfma_f32_32x32x16_bf16 v[64:79], a[8:11], v[20:23], v[64:79]
    ds_read_b128 v[40:43], v11 offset:4096
    v_mul_f32 v118, s92, v118
    v_mul_f32 v119, s92, v119
    v_exp_f32 v112, v112
    v_exp_f32 v113, v113
    s_waitcnt lgkmcnt(4)
    v_mfma_f32_32x32x16_bf16 v[64:79], a[12:15], v[24:27], v[64:79]
    ds_read_b128 v[20:23], v8 offset:8192
    v_exp_f32 v114, v114
    v_exp_f32 v115, v115
    v_exp_f32 v116, v116
    s_waitcnt lgkmcnt(4)
    v_mfma_f32_32x32x16_bf16 v[64:79], a[16:19], v[28:31], v[64:79]
    ds_read_b128 v[24:27], v9 offset:8192
    v_exp_f32 v117, v117
    v_exp_f32 v118, v118
    v_exp_f32 v119, v119
    v_add_f32 v112, 1.0, v112
    s_waitcnt lgkmcnt(4)
    v_mfma_f32_32x32x16_bf16 v[64:79], a[20:23], v[32:35], v[64:79]
    ds_read_b128 v[28:31], v10 offset:8192
    v_add_f32 v113, 1.0, v113
    v_add_f32 v114, 1.0, v114
    v_add_f32 v115, 1.0, v115
    v_add_f32 v116, 1.0, v116
    v_add_f32 v117, 1.0, v117
    v_add_f32 v118, 1.0, v118
    v_add_f32 v119, 1.0, v119
    s_waitcnt lgkmcnt(4)
    v_mfma_f32_32x32x16_bf16 v[64:79], a[24:27], v[36:39], v[64:79]
    ds_read_b128 v[32:35], v11 offset:8192
    v_rcp_f32 v112, v112
    v_rcp_f32 v113, v113
    v_rcp_f32 v114, v114
    s_waitcnt lgkmcnt(4)
    v_mfma_f32_32x32x16_bf16 v[64:79], a[28:31], v[40:43], v[64:79]
    ds_read_b128 v[36:39], v8 offset:12288
    v_rcp_f32 v115, v115
    v_rcp_f32 v116, v116
    v_rcp_f32 v117, v117
    s_waitcnt lgkmcnt(4)
    v_mfma_f32_32x32x16_bf16 v[64:79], a[32:35], v[20:23], v[64:79]
    ds_read_b128 v[40:43], v9 offset:12288
    v_rcp_f32 v118, v118
    v_rcp_f32 v119, v119
    v_mul_f32 v120, v112, v120
    v_mul_f32 v121, v113, v121
    v_mul_f32 v122, v114, v122
    s_waitcnt lgkmcnt(4)
    v_mfma_f32_32x32x16_bf16 v[64:79], a[36:39], v[24:27], v[64:79]
    ds_read_b128 v[20:23], v10 offset:12288
    v_mul_f32 v123, v115, v123
    v_mul_f32 v124, v116, v124
    v_mul_f32 v125, v117, v125
    v_mul_f32 v126, v118, v126
    v_mul_f32 v127, v119, v127
    v_cvt_pk_bf16_f32 v112, v120, v121
    v_cvt_pk_bf16_f32 v113, v122, v123
    s_waitcnt lgkmcnt(4)
    v_mfma_f32_32x32x16_bf16 v[64:79], a[40:43], v[28:31], v[64:79]
    ds_read_b128 v[24:27], v11 offset:12288
    v_cvt_pk_bf16_f32 v114, v124, v125
    v_cvt_pk_bf16_f32 v115, v126, v127
    s_add_u32 s96, s8, 6
    s_and_b32 s96, s96, 63
    s_mul_i32 s96, s96, 147456
    s_add_u32 s96, s96, s90
    buffer_store_dwordx4 v[112:115], v6, s[52:55], s96 offen sc1
    s_nop 0
    s_waitcnt lgkmcnt(4)
    v_mfma_f32_32x32x16_bf16 v[64:79], a[44:47], v[32:35], v[64:79]
    ds_read_b128 v[28:31], v8 offset:16384
    s_waitcnt lgkmcnt(4)
    v_mfma_f32_32x32x16_bf16 v[64:79], a[48:51], v[36:39], v[64:79]
    ds_read_b128 v[32:35], v9 offset:16384
    s_waitcnt lgkmcnt(4)
    v_mfma_f32_32x32x16_bf16 v[64:79], a[52:55], v[40:43], v[64:79]
    ds_read_b128 v[36:39], v10 offset:16384
    s_waitcnt lgkmcnt(4)
    v_mfma_f32_32x32x16_bf16 v[64:79], a[56:59], v[20:23], v[64:79]
    ds_read_b128 v[40:43], v11 offset:16384
    s_waitcnt lgkmcnt(4)
    v_mfma_f32_32x32x16_bf16 v[64:79], a[60:63], v[24:27], v[64:79]
    ds_read_b128 v[20:23], v8 offset:20480
    s_waitcnt lgkmcnt(4)
    v_mfma_f32_32x32x16_bf16 v[64:79], a[64:67], v[28:31], v[64:79]
    ds_read_b128 v[24:27], v9 offset:20480
    s_waitcnt lgkmcnt(4)
    v_mfma_f32_32x32x16_bf16 v[64:79], a[68:71], v[32:35], v[64:79]
    ds_read_b128 v[28:31], v10 offset:20480
    s_waitcnt lgkmcnt(4)
    v_mfma_f32_32x32x16_bf16 v[64:79], a[72:75], v[36:39], v[64:79]
    ds_read_b128 v[32:35], v11 offset:20480
    s_waitcnt lgkmcnt(4)
    v_mfma_f32_32x32x16_bf16 v[64:79], a[76:79], v[40:43], v[64:79]
    ds_read_b128 v[36:39], v8 offset:24576
    s_waitcnt lgkmcnt(4)
    v_mfma_f32_32x32x16_bf16 v[64:79], a[80:83], v[20:23], v[64:79]
    ds_read_b128 v[40:43], v9 offset:24576
    s_waitcnt lgkmcnt(4)
    v_mfma_f32_32x32x16_bf16 v[64:79], a[84:87], v[24:27], v[64:79]
    ds_read_b128 v[20:23], v10 offset:24576
    s_waitcnt lgkmcnt(4)
    v_mfma_f32_32x32x16_bf16 v[64:79], a[88:91], v[28:31], v[64:79]
    ds_read_b128 v[24:27], v11 offset:24576
    s_waitcnt lgkmcnt(4)
    v_mfma_f32_32x32x16_bf16 v[64:79], a[92:95], v[32:35], v[64:79]
    ds_read_b128 v[28:31], v8 offset:28672
    s_waitcnt lgkmcnt(4)
    v_mfma_f32_32x32x16_bf16 v[64:79], a[96:99], v[36:39], v[64:79]
    ds_read_b128 v[32:35], v9 offset:28672
    s_waitcnt lgkmcnt(4)
    v_mfma_f32_32x32x16_bf16 v[64:79], a[100:103], v[40:43], v[64:79]
    ds_read_b128 v[36:39], v10 offset:28672
    s_waitcnt lgkmcnt(4)
    v_mfma_f32_32x32x16_bf16 v[64:79], a[104:107], v[20:23], v[64:79]
    ds_read_b128 v[40:43], v11 offset:28672
    s_waitcnt vmcnt(1) lgkmcnt(0)
    s_barrier
    v_add_u32 v8, s37, v8
    v_add_u32 v9, s37, v9
    v_add_u32 v10, s37, v10
    v_add_u32 v11, s37, v11
    v_mfma_f32_32x32x16_bf16 v[64:79], a[108:111], v[24:27], v[64:79]
    ds_read_b128 v[20:23], v8 offset:0
    v_mfma_f32_32x32x16_bf16 v[64:79], a[112:115], v[28:31], v[64:79]
    ds_read_b128 v[24:27], v9 offset:0
    v_mfma_f32_32x32x16_bf16 v[64:79], a[116:119], v[32:35], v[64:79]
    ds_read_b128 v[28:31], v10 offset:0
    v_mfma_f32_32x32x16_bf16 v[64:79], a[120:123], v[36:39], v[64:79]
    ds_read_b128 v[32:35], v11 offset:0
    v_mfma_f32_32x32x16_bf16 v[64:79], a[124:127], v[40:43], v[64:79]
    ds_read_b128 v[36:39], v8 offset:4096
    s_lshr_b32 s12, s97, 2
    s_or_b32 s12, s12, s100
    s_cmp_eq_u32 s12, 0
    s_cbranch_scc1 K1_mlp_last
    s_nop 7
    v_mul_f32 v72, v64, v72
    v_mul_f32 v73, v65, v73
    v_mul_f32 v74, v66, v74
    v_mul_f32 v75, v67, v75
    v_mul_f32 v76, v68, v76
    v_mul_f32 v77, v69, v77
    v_mul_f32 v78, v70, v78
    v_mul_f32 v79, v71, v79
    v_mul_f32 v64, s92, v64
    v_mul_f32 v65, s92, v65
    v_mul_f32 v66, s92, v66
    v_mul_f32 v67, s92, v67
    v_mul_f32 v68, s92, v68
    v_mul_f32 v69, s92, v69
    v_mul_f32 v70, s92, v70
    v_mul_f32 v71, s92, v71
    v_exp_f32 v64, v64
    v_exp_f32 v65, v65
    v_exp_f32 v66, v66
    v_exp_f32 v67, v67
    v_exp_f32 v68, v68
    v_exp_f32 v69, v69
    v_exp_f32 v70, v70
    v_exp_f32 v71, v71
    v_add_f32 v64, 1.0, v64
    v_add_f32 v65, 1.0, v65
    v_add_f32 v66, 1.0, v66
    v_add_f32 v67, 1.0, v67
    v_add_f32 v68, 1.0, v68
    v_add_f32 v69, 1.0, v69
    v_add_f32 v70, 1.0, v70
    v_add_f32 v71, 1.0, v71
    v_rcp_f32 v64, v64
    v_rcp_f32 v65, v65
    v_rcp_f32 v66, v66
    v_rcp_f32 v67, v67
    v_rcp_f32 v68, v68
    v_rcp_f32 v69, v69
    v_rcp_f32 v70, v70
    v_rcp_f32 v71, v71
    v_mul_f32 v72, v64, v72
    v_mul_f32 v73, v65, v73
    v_mul_f32 v74, v66, v74
    v_mul_f32 v75, v67, v75
    v_mul_f32 v76, v68, v76
    v_mul_f32 v77, v69, v77
    v_mul_f32 v78, v70, v78
    v_mul_f32 v79, v71, v79
    v_cvt_pk_bf16_f32 v64, v72, v73
    v_cvt_pk_bf16_f32 v65, v74, v75
    v_cvt_pk_bf16_f32 v66, v76, v77
    v_cvt_pk_bf16_f32 v67, v78, v79
    s_add_u32 s96, s8, 8
    s_and_b32 s96, s96, 63
    s_mul_i32 s96, s96, 147456
    s_add_u32 s96, s96, s90
    buffer_store_dwordx4 v[64:67], v6, s[52:55], s96 offen sc1
    s_nop 0
    s_endpgm
K1_mlp_last:
    s_waitcnt lgkmcnt(4)
    v_mfma_f32_32x32x16_bf16 v[80:95], a[0:3], v[20:23], 0
    ds_read_b128 v[40:43], v9 offset:4096
    s_nop 8
    v_mul_f32 v72, v64, v72
    v_mul_f32 v73, v65, v73
    v_mul_f32 v74, v66, v74
    v_mul_f32 v75, v67, v75
    v_mul_f32 v76, v68, v76
    s_waitcnt lgkmcnt(4)
    v_mfma_f32_32x32x16_bf16 v[80:95], a[4:7], v[24:27], v[80:95]
    ds_read_b128 v[20:23], v10 offset:4096
    v_mul_f32 v77, v69, v77
    v_mul_f32 v78, v70, v78
    v_mul_f32 v79, v71, v79
    v_mul_f32 v64, s92, v64
    v_mul_f32 v65, s92, v65
    s_waitcnt lgkmcnt(4)
    v_mfma_f32_32x32x16_bf16 v[80:95], a[8:11], v[28:31], v[80:95]
    ds_read_b128 v[24:27], v11 offset:4096
    v_mul_f32 v66, s92, v66
    v_mul_f32 v67, s92, v67
    v_mul_f32 v68, s92, v68
    v_mul_f32 v69, s92, v69
    v_mul_f32 v70, s92, v70
    s_waitcnt lgkmcnt(4)
    v_mfma_f32_32x32x16_bf16 v[80:95], a[12:15], v[32:35], v[80:95]
    ds_read_b128 v[28:31], v8 offset:8192
    v_mul_f32 v71, s92, v71
    v_exp_f32 v64, v64
    v_exp_f32 v65, v65
    s_waitcnt lgkmcnt(4)
    v_mfma_f32_32x32x16_bf16 v[80:95], a[16:19], v[36:39], v[80:95]
    ds_read_b128 v[32:35], v9 offset:8192
    v_exp_f32 v66, v66
    v_exp_f32 v67, v67
    s_waitcnt lgkmcnt(4)
    v_mfma_f32_32x32x16_bf16 v[80:95], a[20:23], v[40:43], v[80:95]
    ds_read_b128 v[36:39], v10 offset:8192
    v_exp_f32 v68, v68
    v_exp_f32 v69, v69
    s_waitcnt lgkmcnt(4)
    v_mfma_f32_32x32x16_bf16 v[80:95], a[24:27], v[20:23], v[80:95]
    ds_read_b128 v[40:43], v11 offset:8192
    v_exp_f32 v70, v70
    v_exp_f32 v71, v71
    v_add_f32 v64, 1.0, v64
    s_waitcnt lgkmcnt(4)
    v_mfma_f32_32x32x16_bf16 v[80:95], a[28:31], v[24:27], v[80:95]
    ds_read_b128 v[20:23], v8 offset:12288
    v_add_f32 v65, 1.0, v65
    v_add_f32 v66, 1.0, v66
    v_add_f32 v67, 1.0, v67
    v_add_f32 v68, 1.0, v68
    v_add_f32 v69, 1.0, v69
    s_waitcnt lgkmcnt(4)
    v_mfma_f32_32x32x16_bf16 v[80:95], a[32:35], v[28:31], v[80:95]
    ds_read_b128 v[24:27], v9 offset:12288
    v_add_f32 v70, 1.0, v70
    v_add_f32 v71, 1.0, v71
    v_rcp_f32 v64, v64
    s_waitcnt lgkmcnt(4)
    v_mfma_f32_32x32x16_bf16 v[80:95], a[36:39], v[32:35], v[80:95]
    ds_read_b128 v[28:31], v10 offset:12288
    v_rcp_f32 v65, v65
    v_rcp_f32 v66, v66
    s_waitcnt lgkmcnt(4)
    v_mfma_f32_32x32x16_bf16 v[80:95], a[40:43], v[36:39], v[80:95]
    ds_read_b128 v[32:35], v11 offset:12288
    v_rcp_f32 v67, v67
    v_rcp_f32 v68, v68
    s_waitcnt lgkmcnt(4)
    v_mfma_f32_32x32x16_bf16 v[80:95], a[44:47], v[40:43], v[80:95]
    ds_read_b128 v[36:39], v8 offset:16384
    v_rcp_f32 v69, v69
    v_rcp_f32 v70, v70
    s_waitcnt lgkmcnt(4)
    v_mfma_f32_32x32x16_bf16 v[80:95], a[48:51], v[20:23], v[80:95]
    ds_read_b128 v[40:43], v9 offset:16384
    v_rcp_f32 v71, v71
    v_mul_f32 v72, v64, v72
    v_mul_f32 v73, v65, v73
    v_mul_f32 v74, v66, v74
    s_waitcnt lgkmcnt(4)
    v_mfma_f32_32x32x16_bf16 v[80:95], a[52:55], v[24:27], v[80:95]
    ds_read_b128 v[20:23], v10 offset:16384
    v_mul_f32 v75, v67, v75
    v_mul_f32 v76, v68, v76
    v_mul_f32 v77, v69, v77
    v_mul_f32 v78, v70, v78
    v_mul_f32 v79, v71, v79
    s_waitcnt lgkmcnt(4)
    v_mfma_f32_32x32x16_bf16 v[80:95], a[56:59], v[28:31], v[80:95]
    ds_read_b128 v[24:27], v11 offset:16384
    v_cvt_pk_bf16_f32 v64, v72, v73
    v_cvt_pk_bf16_f32 v65, v74, v75
    v_cvt_pk_bf16_f32 v66, v76, v77
    v_cvt_pk_bf16_f32 v67, v78, v79
    s_waitcnt lgkmcnt(4)
    v_mfma_f32_32x32x16_bf16 v[80:95], a[60:63], v[32:35], v[80:95]
    ds_read_b128 v[28:31], v8 offset:20480
    s_add_u32 s96, s8, 8
    s_and_b32 s96, s96, 63
    s_mul_i32 s96, s96, 147456
    s_add_u32 s96, s96, s90
    buffer_store_dwordx4 v[64:67], v6, s[52:55], s96 offen sc1
    s_nop 0
    s_waitcnt lgkmcnt(4)
    v_mfma_f32_32x32x16_bf16 v[80:95], a[64:67], v[36:39], v[80:95]
    ds_read_b128 v[32:35], v9 offset:20480
    s_waitcnt lgkmcnt(4)
    v_mfma_f32_32x32x16_bf16 v[80:95], a[68:71], v[40:43], v[80:95]
    ds_read_b128 v[36:39], v10 offset:20480
    s_waitcnt lgkmcnt(4)
    v_mfma_f32_32x32x16_bf16 v[80:95], a[72:75], v[20:23], v[80:95]
    ds_read_b128 v[40:43], v11 offset:20480
    s_waitcnt lgkmcnt(4)
    v_mfma_f32_32x32x16_bf16 v[80:95], a[76:79], v[24:27], v[80:95]
    ds_read_b128 v[20:23], v8 offset:24576
    s_waitcnt lgkmcnt(4)
    v_mfma_f32_32x32x16_bf16 v[80:95], a[80:83], v[28:31], v[80:95]
    ds_read_b128 v[24:27], v9 offset:24576
    s_waitcnt lgkmcnt(4)
    v_mfma_f32_32x32x16_bf16 v[80:95], a[84:87], v[32:35], v[80:95]
    ds_read_b128 v[28:31], v10 offset:24576
    s_waitcnt lgkmcnt(4)
    v_mfma_f32_32x32x16_bf16 v[80:95], a[88:91], v[36:39], v[80:95]
    ds_read_b128 v[32:35], v11 offset:24576
    s_waitcnt lgkmcnt(4)
    v_mfma_f32_32x32x16_bf16 v[80:95], a[92:95], v[40:43], v[80:95]
    ds_read_b128 v[36:39], v8 offset:28672
    s_waitcnt lgkmcnt(4)
    v_mfma_f32_32x32x16_bf16 v[80:95], a[96:99], v[20:23], v[80:95]
    ds_read_b128 v[40:43], v9 offset:28672
    s_waitcnt lgkmcnt(4)
    v_mfma_f32_32x32x16_bf16 v[80:95], a[100:103], v[24:27], v[80:95]
    ds_read_b128 v[20:23], v10 offset:28672
    s_waitcnt lgkmcnt(4)
    v_mfma_f32_32x32x16_bf16 v[80:95], a[104:107], v[28:31], v[80:95]
    ds_read_b128 v[24:27], v11 offset:28672
    s_waitcnt lgkmcnt(4)
    v_mfma_f32_32x32x16_bf16 v[80:95], a[108:111], v[32:35], v[80:95]
    s_waitcnt lgkmcnt(3)
    v_mfma_f32_32x32x16_bf16 v[80:95], a[112:115], v[36:39], v[80:95]
    s_waitcnt lgkmcnt(2)
    v_mfma_f32_32x32x16_bf16 v[80:95], a[116:119], v[40:43], v[80:95]
    s_waitcnt lgkmcnt(1)
    v_mfma_f32_32x32x16_bf16 v[80:95], a[120:123], v[20:23], v[80:95]
    s_waitcnt lgkmcnt(0)
    v_mfma_f32_32x32x16_bf16 v[80:95], a[124:127], v[24:27], v[80:95]
    s_nop 12
    v_mul_f32 v88, v80, v88
    v_mul_f32 v89, v81, v89
    v_mul_f32 v90, v82, v90
    v_mul_f32 v91, v83, v91
    v_mul_f32 v92, v84, v92
    v_mul_f32 v93, v85, v93
    v_mul_f32 v94, v86, v94
    v_mul_f32 v95, v87, v95
    v_mul_f32 v80, s92, v80
    v_mul_f32 v81, s92, v81
    v_mul_f32 v82, s92, v82
    v_mul_f32 v83, s92, v83
    v_mul_f32 v84, s92, v84
    v_mul_f32 v85, s92, v85
    v_mul_f32 v86, s92, v86
    v_mul_f32 v87, s92, v87
    v_exp_f32 v80, v80
    v_exp_f32 v81, v81
    v_exp_f32 v82, v82
    v_exp_f32 v83, v83
    v_exp_f32 v84, v84
    v_exp_f32 v85, v85
    v_exp_f32 v86, v86
    v_exp_f32 v87, v87
    v_add_f32 v80, 1.0, v80
    v_add_f32 v81, 1.0, v81
    v_add_f32 v82, 1.0, v82
    v_add_f32 v83, 1.0, v83
    v_add_f32 v84, 1.0, v84
    v_add_f32 v85, 1.0, v85
    v_add_f32 v86, 1.0, v86
    v_add_f32 v87, 1.0, v87
    v_rcp_f32 v80, v80
    v_rcp_f32 v81, v81
    v_rcp_f32 v82, v82
    v_rcp_f32 v83, v83
    v_rcp_f32 v84, v84
    v_rcp_f32 v85, v85
    v_rcp_f32 v86, v86
    v_rcp_f32 v87, v87
    v_mul_f32 v88, v80, v88
    v_mul_f32 v89, v81, v89
    v_mul_f32 v90, v82, v90
    v_mul_f32 v91, v83, v91
    v_mul_f32 v92, v84, v92
    v_mul_f32 v93, v85, v93
    v_mul_f32 v94, v86, v94
    v_mul_f32 v95, v87, v95
    v_cvt_pk_bf16_f32 v80, v88, v89
    v_cvt_pk_bf16_f32 v81, v90, v91
    v_cvt_pk_bf16_f32 v82, v92, v93
    v_cvt_pk_bf16_f32 v83, v94, v95
    s_add_u32 s96, s8, 10
    s_and_b32 s96, s96, 63
    s_mul_i32 s96, s96, 147456
    s_add_u32 s96, s96, s90
    buffer_store_dwordx4 v[80:83], v6, s[52:55], s96 offen sc1
    s_nop 0
    s_endpgm
.p2align 6
K1_q:
    s_lshl_b32 s12, s11, 3
    s_add_u32 s12, s12, s101
    s_sub_u32 s12, s12, 112
    s_lshl_b32 s90, s12, 10
    ds_read_b128 v[32:35], v11 offset:0
    ds_read_b128 v[36:39], v8 offset:4096
    s_waitcnt lgkmcnt(4)
    v_mfma_f32_32x32x16_bf16 v[96:111], a[0:3], v[20:23], 0
    ds_read_b128 v[40:43], v9 offset:4096
    s_add_u32 m0, s88, 57344
    s_add_u32 s96, s10, 229376
    s_and_b32 s96, s96, 0x1fffff
    s_add_u32 s96, s96, s32
    buffer_load_dwordx4 v4, s[40:43], s96 offen lds
    v_mul_f32 v12, s91, v64
    v_mul_f32 v13, s91, v65
    v_mul_f32 v14, s91, v66
    s_waitcnt lgkmcnt(4)
    v_mfma_f32_32x32x16_bf16 v[96:111], a[4:7], v[24:27], v[96:111]
    ds_read_b128 v[20:23], v10 offset:4096
    s_add_u32 m0, s88, 65536
    s_add_u32 s96, s10, 229376
    s_and_b32 s96, s96, 0x1fffff
    s_add_u32 s96, s96, s33
    buffer_load_dwordx4 v4, s[40:43], s96 offen lds
    v_mul_f32 v15, s91, v67
    v_mul_f32 v16, s91, v68
    v_mul_f32 v17, s91, v69
    s_waitcnt lgkmcnt(4)
    v_mfma_f32_32x32x16_bf16 v[96:111], a[8:11], v[28:31], v[96:111]
    ds_read_b128 v[24:27], v11 offset:4096
    v_mul_f32 v18, s91, v70
    v_mul_f32 v19, s91, v71
    v_exp_f32_e64 v12, v12 clamp
    v_exp_f32_e64 v13, v13 clamp
    s_waitcnt lgkmcnt(4)
    v_mfma_f32_32x32x16_bf16 v[96:111], a[12:15], v[32:35], v[96:111]
    ds_read_b128 v[28:31], v8 offset:8192
    v_exp_f32_e64 v14, v14 clamp
    v_exp_f32_e64 v15, v15 clamp
    v_exp_f32_e64 v16, v16 clamp
    s_waitcnt lgkmcnt(4)
    v_mfma_f32_32x32x16_bf16 v[96:111], a[16:19], v[36:39], v[96:111]
    ds_read_b128 v[32:35], v9 offset:8192
    v_exp_f32_e64 v17, v17 clamp
    v_exp_f32_e64 v18, v18 clamp
    v_exp_f32_e64 v19, v19 clamp
    v_max_f32 v64, 0, v64
    s_waitcnt lgkmcnt(4)
    v_mfma_f32_32x32x16_bf16 v[96:111], a[20:23], v[40:43], v[96:111]
    ds_read_b128 v[36:39], v10 offset:8192
    v_max_f32 v65, 0, v65
    v_max_f32 v66, 0, v66
    v_max_f32 v67, 0, v67
    v_max_f32 v68, 0, v68
    v_max_f32 v69, 0, v69
    v_max_f32 v70, 0, v70
    v_max_f32 v71, 0, v71
    s_waitcnt lgkmcnt(4)
    v_mfma_f32_32x32x16_bf16 v[96:111], a[24:27], v[20:23], v[96:111]
    ds_read_b128 v[40:43], v11 offset:8192
    v_add_f32 v64, v64, v12
    v_add_f32 v65, v65, v13
    v_add_f32 v66, v66, v14
    v_add_f32 v67, v67, v15
    v_add_f32 v68, v68, v16
    v_add_f32 v69, v69, v17
    v_add_f32 v70, v70, v18
    s_waitcnt lgkmcnt(4)
    v_mfma_f32_32x32x16_bf16 v[96:111], a[28:31], v[24:27], v[96:111]
    ds_read_b128 v[20:23], v8 offset:12288
    v_add_f32 v71, v71, v19
    v_add_f32 v64, s93, v64
    v_add_f32 v65, s93, v65
    v_add_f32 v66, s93, v66
    v_add_f32 v67, s93, v67
    v_add_f32 v68, s93, v68
    v_add_f32 v69, s93, v69
    s_waitcnt lgkmcnt(4)
    v_mfma_f32_32x32x16_bf16 v[96:111], a[32:35], v[28:31], v[96:111]
    ds_read_b128 v[24:27], v9 offset:12288
    v_add_f32 v70, s93, v70
    v_add_f32 v71, s93, v71
    v_cvt_pk_bf16_f32 v64, v64, v65
    v_cvt_pk_bf16_f32 v65, v66, v67
    v_cvt_pk_bf16_f32 v66, v68, v69
    v_cvt_pk_bf16_f32 v67, v70, v71
    s_waitcnt lgkmcnt(4)
    v_mfma_f32_32x32x16_bf16 v[96:111], a[36:39], v[32:35], v[96:111]
    ds_read_b128 v[28:31], v10 offset:12288
    s_add_u32 s96, s8, 0
    s_and_b32 s96, s96, 63
    s_mul_i32 s96, s96, 147456
    s_add_u32 s96, s96, s90
    buffer_store_dwordx4 v[64:67], v6, s[52:55], s96 offen sc1
    s_nop 0
    v_mul_f32 v12, s91, v72
    v_mul_f32 v13, s91, v73
    v_mul_f32 v14, s91, v74
    v_mul_f32 v15, s91, v75
    s_waitcnt lgkmcnt(4)
    v_mfma_f32_32x32x16_bf16 v[96:111], a[40:43], v[36:39], v[96:111]
    ds_read_b128 v[32:35], v11 offset:12288
    v_mul_f32 v16, s91, v76
    v_mul_f32 v17, s91, v77
    v_mul_f32 v18, s91, v78
    v_mul_f32 v19, s91, v79
    v_exp_f32_e64 v12, v12 clamp
    s_waitcnt lgkmcnt(4)
    v_mfma_f32_32x32x16_bf16 v[96:111], a[44:47], v[40:43], v[96:111]
    ds_read_b128 v[36:39], v8 offset:16384
    v_exp_f32_e64 v13, v13 clamp
    v_exp_f32_e64 v14, v14 clamp
    v_exp_f32_e64 v15, v15 clamp
    s_waitcnt lgkmcnt(4)
    v_mfma_f32_32x32x16_bf16 v[96:111], a[48:51], v[20:23], v[96:111]
    ds_read_b128 v[40:43], v9 offset:16384
    v_exp_f32_e64 v16, v16 clamp
    v_exp_f32_e64 v17, v17 clamp
    v_exp_f32_e64 v18, v18 clamp
    s_waitcnt lgkmcnt(4)
    v_mfma_f32_32x32x16_bf16 v[96:111], a[52:55], v[24:27], v[96:111]
    ds_read_b128 v[20:23], v10 offset:16384
    v_exp_f32_e64 v19, v19 clamp
    v_max_f32 v72, 0, v72
    v_max_f32 v73, 0, v73
    v_max_f32 v74, 0, v74
    v_max_f32 v75, 0, v75
    v_max_f32 v76, 0, v76
    s_waitcnt lgkmcnt(4)
    v_mfma_f32_32x32x16_bf16 v[96:111], a[56:59], v[28:31], v[96:111]
    ds_read_b128 v[24:27], v11 offset:16384
    v_max_f32 v77, 0, v77
    v_max_f32 v78, 0, v78
    v_max_f32 v79, 0, v79
    v_add_f32 v72, v72, v12
    v_add_f32 v73, v73, v13
    v_add_f32 v74, v74, v14
    v_add_f32 v75, v75, v15
    s_waitcnt lgkmcnt(4)
    v_mfma_f32_32x32x16_bf16 v[96:111], a[60:63], v[32:35], v[96:111]
    ds_read_b128 v[28:31], v8 offset:20480
    v_add_f32 v76, v76, v16
    v_add_f32 v77, v77, v17
    v_add_f32 v78, v78, v18
    v_add_f32 v79, v79, v19
    v_add_f32 v72, s93, v72
    v_add_f32 v73, s93, v73
    v_add_f32 v74, s93, v74
    s_waitcnt lgkmcnt(4)
    v_mfma_f32_32x32x16_bf16 v[96:111], a[64:67], v[36:39], v[96:111]
    ds_read_b128 v[32:35], v9 offset:20480
    v_add_f32 v75, s93, v75
    v_add_f32 v76, s93, v76
    v_add_f32 v77, s93, v77
    v_add_f32 v78, s93, v78
    v_add_f32 v79, s93, v79
    v_cvt_pk_bf16_f32 v72, v72, v73
    v_cvt_pk_bf16_f32 v73, v74, v75
    s_waitcnt lgkmcnt(4)
    v_mfma_f32_32x32x16_bf16 v[96:111], a[68:71], v[40:43], v[96:111]
    ds_read_b128 v[36:39], v10 offset:20480
    v_cvt_pk_bf16_f32 v74, v76, v77
    v_cvt_pk_bf16_f32 v75, v78, v79
    s_add_u32 s96, s8, 0
    s_and_b32 s96, s96, 63
    s_mul_i32 s96, s96, 147456
    s_add_u32 s96, s96, s90
    s_add_u32 s96, s96, 4096
    buffer_store_dwordx4 v[72:75], v6, s[52:55], s96 offen sc1
    s_nop 0
    v_mul_f32 v12, s91, v80
    v_mul_f32 v13, s91, v81
    s_waitcnt lgkmcnt(4)
    v_mfma_f32_32x32x16_bf16 v[96:111], a[72:75], v[20:23], v[96:111]
    ds_read_b128 v[40:43], v11 offset:20480
    v_mul_f32 v14, s91, v82
    v_mul_f32 v15, s91, v83
    v_mul_f32 v16, s91, v84
    v_mul_f32 v17, s91, v85
    v_mul_f32 v18, s91, v86
    v_mul_f32 v19, s91, v87
    s_waitcnt lgkmcnt(4)
    v_mfma_f32_32x32x16_bf16 v[96:111], a[76:79], v[24:27], v[96:111]
    ds_read_b128 v[20:23], v8 offset:24576
    v_exp_f32_e64 v12, v12 clamp
    v_exp_f32_e64 v13, v13 clamp
    v_exp_f32_e64 v14, v14 clamp
    s_waitcnt lgkmcnt(4)
    v_mfma_f32_32x32x16_bf16 v[96:111], a[80:83], v[28:31], v[96:111]
    ds_read_b128 v[24:27], v9 offset:24576
    v_exp_f32_e64 v15, v15 clamp
    v_exp_f32_e64 v16, v16 clamp
    v_exp_f32_e64 v17, v17 clamp
    s_waitcnt lgkmcnt(4)
    v_mfma_f32_32x32x16_bf16 v[96:111], a[84:87], v[32:35], v[96:111]
    ds_read_b128 v[28:31], v10 offset:24576
    v_exp_f32_e64 v18, v18 clamp
    v_exp_f32_e64 v19, v19 clamp
    v_max_f32 v80, 0, v80
    v_max_f32 v81, 0, v81
    v_max_f32 v82, 0, v82
    s_waitcnt lgkmcnt(4)
    v_mfma_f32_32x32x16_bf16 v[96:111], a[88:91], v[36:39], v[96:111]
    ds_read_b128 v[32:35], v11 offset:24576
    v_max_f32 v83, 0, v83
    v_max_f32 v84, 0, v84
    v_max_f32 v85, 0, v85
    v_max_f32 v86, 0, v86
    v_max_f32 v87, 0, v87
    v_add_f32 v80, v80, v12
    v_add_f32 v81, v81, v13
    s_waitcnt lgkmcnt(4)
    v_mfma_f32_32x32x16_bf16 v[96:111], a[92:95], v[40:43], v[96:111]
    ds_read_b128 v[36:39], v8 offset:28672
    v_add_f32 v82, v82, v14
    v_add_f32 v83, v83, v15
    v_add_f32 v84, v84, v16
    v_add_f32 v85, v85, v17
    v_add_f32 v86, v86, v18
    v_add_f32 v87, v87, v19
    v_add_f32 v80, s93, v80
    s_waitcnt lgkmcnt(4)
    v_mfma_f32_32x32x16_bf16 v[96:111], a[96:99], v[20:23], v[96:111]
    ds_read_b128 v[40:43], v9 offset:28672
    v_add_f32 v81, s93, v81
    v_add_f32 v82, s93, v82
    v_add_f32 v83, s93, v83
    v_add_f32 v84, s93, v84
    v_add_f32 v85, s93, v85
    v_add_f32 v86, s93, v86
    v_add_f32 v87, s93, v87
    s_waitcnt lgkmcnt(4)
    v_mfma_f32_32x32x16_bf16 v[96:111], a[100:103], v[24:27], v[96:111]
    ds_read_b128 v[20:23], v10 offset:28672
    v_cvt_pk_bf16_f32 v80, v80, v81
    v_cvt_pk_bf16_f32 v81, v82, v83
    v_cvt_pk_bf16_f32 v82, v84, v85
    v_cvt_pk_bf16_f32 v83, v86, v87
    s_add_u32 s96, s8, 2
    s_and_b32 s96, s96, 63
    s_mul_i32 s96, s96, 147456
    s_add_u32 s96, s96, s90
    buffer_store_dwordx4 v[80:83], v6, s[52:55], s96 offen sc1
    s_nop 0
    s_waitcnt lgkmcnt(4)
    v_mfma_f32_32x32x16_bf16 v[96:111], a[104:107], v[28:31], v[96:111]
    ds_read_b128 v[24:27], v11 offset:28672
    v_mul_f32 v12, s91, v88
    v_mul_f32 v13, s91, v89
    v_mul_f32 v14, s91, v90
    v_mul_f32 v15, s91, v91
    v_mul_f32 v16, s91, v92
    v_mul_f32 v17, s91, v93
    v_mul_f32 v18, s91, v94
    s_waitcnt vmcnt(3) lgkmcnt(0)
    s_barrier
    v_add_u32 v8, s35, v8
    v_add_u32 v9, s35, v9
    v_add_u32 v10, s35, v10
    v_add_u32 v11, s35, v11
    v_mfma_f32_32x32x16_bf16 v[96:111], a[108:111], v[32:35], v[96:111]
    ds_read_b128 v[28:31], v8 offset:0
    s_add_u32 m0, s88, 122880
    s_add_u32 s96, s10, 262144
    s_and_b32 s96, s96, 0x1fffff
    s_add_u32 s96, s96, s30
    buffer_load_dwordx4 v4, s[40:43], s96 offen lds
    v_mul_f32 v19, s91, v95
    v_exp_f32_e64 v12, v12 clamp
    v_mfma_f32_32x32x16_bf16 v[96:111], a[112:115], v[36:39], v[96:111]
    ds_read_b128 v[32:35], v9 offset:0
    s_add_u32 m0, s88, 131072
    s_add_u32 s96, s10, 262144
    s_and_b32 s96, s96, 0x1fffff
    s_add_u32 s96, s96, s31
    buffer_load_dwordx4 v4, s[40:43], s96 offen lds
    v_exp_f32_e64 v13, v13 clamp
    v_mfma_f32_32x32x16_bf16 v[96:111], a[116:119], v[40:43], v[96:111]
    ds_read_b128 v[36:39], v10 offset:0
    s_add_u32 m0, s88, 139264
    s_add_u32 s96, s10, 262144
    s_and_b32 s96, s96, 0x1fffff
    s_add_u32 s96, s96, s32
    buffer_load_dwordx4 v4, s[40:43], s96 offen lds
    v_exp_f32_e64 v14, v14 clamp
    v_mfma_f32_32x32x16_bf16 v[96:111], a[120:123], v[20:23], v[96:111]
    ds_read_b128 v[40:43], v11 offset:0
    s_add_u32 m0, s88, 147456
    s_add_u32 s96, s10, 262144
    s_and_b32 s96, s96, 0x1fffff
    s_add_u32 s96, s96, s33
    buffer_load_dwordx4 v4, s[40:43], s96 offen lds
    v_exp_f32_e64 v15, v15 clamp
    v_mfma_f32_32x32x16_bf16 v[96:111], a[124:127], v[24:27], v[96:111]
    ds_read_b128 v[20:23], v8 offset:4096
    s_add_u32 m0, s88, 81920
    s_add_u32 s96, s10, 294912
    s_and_b32 s96, s96, 0x1fffff
    s_add_u32 s96, s96, s30
    buffer_load_dwordx4 v4, s[40:43], s96 offen lds
    v_exp_f32_e64 v16, v16 clamp
    s_waitcnt lgkmcnt(4)
    v_mfma_f32_32x32x16_bf16 v[112:127], a[0:3], v[28:31], 0
    ds_read_b128 v[24:27], v9 offset:4096
    s_add_u32 m0, s88, 90112
    s_add_u32 s96, s10, 294912
    s_and_b32 s96, s96, 0x1fffff
    s_add_u32 s96, s96, s31
    buffer_load_dwordx4 v4, s[40:43], s96 offen lds
    v_exp_f32_e64 v17, v17 clamp
    s_waitcnt lgkmcnt(4)
    v_mfma_f32_32x32x16_bf16 v[112:127], a[4:7], v[32:35], v[112:127]
    ds_read_b128 v[28:31], v10 offset:4096
    s_add_u32 m0, s88, 98304
    s_add_u32 s96, s10, 294912
    s_and_b32 s96, s96, 0x1fffff
    s_add_u32 s96, s96, s32
    buffer_load_dwordx4 v4, s[40:43], s96 offen lds
    v_exp_f32_e64 v18, v18 clamp
    s_waitcnt lgkmcnt(4)
    v_mfma_f32_32x32x16_bf16 v[112:127], a[8:11], v[36:39], v[112:127]
    ds_read_b128 v[32:35], v11 offset:4096
    s_add_u32 m0, s88, 106496
    s_add_u32 s96, s10, 294912
    s_and_b32 s96, s96, 0x1fffff
    s_add_u32 s96, s96, s33
    buffer_load_dwordx4 v4, s[40:43], s96 offen lds
    v_exp_f32_e64 v19, v19 clamp
    v_max_f32 v88, 0, v88
    s_waitcnt lgkmcnt(4)
    v_mfma_f32_32x32x16_bf16 v[112:127], a[12:15], v[40:43], v[112:127]
    ds_read_b128 v[36:39], v8 offset:8192
    v_max_f32 v89, 0, v89
    v_max_f32 v90, 0, v90
    v_max_f32 v91, 0, v91
    v_max_f32 v92, 0, v92
    v_max_f32 v93, 0, v93
    v_max_f32 v94, 0, v94
    v_max_f32 v95, 0, v95
    s_waitcnt lgkmcnt(4)
    v_mfma_f32_32x32x16_bf16 v[112:127], a[16:19], v[20:23], v[112:127]
    ds_read_b128 v[40:43], v9 offset:8192
    s_lshl_b32 s12, s5, 3
    s_add_u32 s12, s12, s6
    s_mul_i32 s12, s12, 12288
    s_and_b32 s13, s4, 1
    s_lshl_b32 s13, s13, 9
    s_add_u32 s12, s12, s13
    v_lshrrev_b32 v45, 2, v1
    v_lshlrev_b32 v45, 10, v45
    v_and_b32 v46, 3, v1
    v_lshl_add_u32 v45, v46, 7, v45
    v_add_u32 v45, s12, v45
    v_subrev_u32 v46, 1835008, v45
    s_mov_b32 exec_hi, 0xffff
    buffer_load_dword v44, v45, s[64:67], 0 offen
    buffer_load_dword v44, v46, s[68:71], 0 offen
    s_mov_b64 exec, -1
    v_add_f32 v88, v88, v12
    v_add_f32 v89, v89, v13
    v_add_f32 v90, v90, v14
    s_waitcnt lgkmcnt(4)
    v_mfma_f32_32x32x16_bf16 v[112:127], a[20:23], v[24:27], v[112:127]
    ds_read_b128 v[20:23], v10 offset:8192
    v_add_f32 v91, v91, v15
    v_add_f32 v92, v92, v16
    v_add_f32 v93, v93, v17
    v_add_f32 v94, v94, v18
    v_add_f32 v95, v95, v19
    v_add_f32 v88, s93, v88
    v_add_f32 v89, s93, v89
    s_waitcnt lgkmcnt(4)
    v_mfma_f32_32x32x16_bf16 v[112:127], a[24:27], v[28:31], v[112:127]
    ds_read_b128 v[24:27], v11 offset:8192
    v_add_f32 v90, s93, v90
    v_add_f32 v91, s93, v91
    v_add_f32 v92, s93, v92
    v_add_f32 v93, s93, v93
    v_add_f32 v94, s93, v94
    v_add_f32 v95, s93, v95
    v_cvt_pk_bf16_f32 v88, v88, v89
    s_waitcnt lgkmcnt(4)
    v_mfma_f32_32x32x16_bf16 v[112:127], a[28:31], v[32:35], v[112:127]
    ds_read_b128 v[28:31], v8 offset:12288
    v_cvt_pk_bf16_f32 v89, v90, v91
    v_cvt_pk_bf16_f32 v90, v92, v93
    v_cvt_pk_bf16_f32 v91, v94, v95
    s_add_u32 s96, s8, 2
    s_and_b32 s96, s96, 63
    s_mul_i32 s96, s96, 147456
    s_add_u32 s96, s96, s90
    s_add_u32 s96, s96, 4096
    buffer_store_dwordx4 v[88:91], v6, s[52:55], s96 offen sc1
    s_nop 0
    v_mul_f32 v12, s91, v96
    s_waitcnt lgkmcnt(4)
    v_mfma_f32_32x32x16_bf16 v[112:127], a[32:35], v[36:39], v[112:127]
    ds_read_b128 v[32:35], v9 offset:12288
    v_mul_f32 v13, s91, v97
    v_mul_f32 v14, s91, v98
    v_mul_f32 v15, s91, v99
    v_mul_f32 v16, s91, v100
    v_mul_f32 v17, s91, v101
    v_mul_f32 v18, s91, v102
    v_mul_f32 v19, s91, v103
    s_waitcnt lgkmcnt(4)
    v_mfma_f32_32x32x16_bf16 v[112:127], a[36:39], v[40:43], v[112:127]
    ds_read_b128 v[36:39], v10 offset:12288
    v_exp_f32_e64 v12, v12 clamp
    v_exp_f32_e64 v13, v13 clamp
    v_exp_f32_e64 v14, v14 clamp
    s_waitcnt lgkmcnt(4)
    v_mfma_f32_32x32x16_bf16 v[112:127], a[40:43], v[20:23], v[112:127]
    ds_read_b128 v[40:43], v11 offset:12288
    v_exp_f32_e64 v15, v15 clamp
    v_exp_f32_e64 v16, v16 clamp
    v_exp_f32_e64 v17, v17 clamp
    s_waitcnt lgkmcnt(4)
    v_mfma_f32_32x32x16_bf16 v[112:127], a[44:47], v[24:27], v[112:127]
    ds_read_b128 v[20:23], v8 offset:16384
    v_exp_f32_e64 v18, v18 clamp
    v_exp_f32_e64 v19, v19 clamp
    v_max_f32 v96, 0, v96
    v_max_f32 v97, 0, v97
    v_max_f32 v98, 0, v98
    s_waitcnt lgkmcnt(4)
    v_mfma_f32_32x32x16_bf16 v[112:127], a[48:51], v[28:31], v[112:127]
    ds_read_b128 v[24:27], v9 offset:16384
    v_max_f32 v99, 0, v99
    v_max_f32 v100, 0, v100
    v_max_f32 v101, 0, v101
    v_max_f32 v102, 0, v102
    v_max_f32 v103, 0, v103
    v_add_f32 v96, v96, v12
    v_add_f32 v97, v97, v13
    s_waitcnt lgkmcnt(4)
    v_mfma_f32_32x32x16_bf16 v[112:127], a[52:55], v[32:35], v[112:127]
    ds_read_b128 v[28:31], v10 offset:16384
    v_add_f32 v98, v98, v14
    v_add_f32 v99, v99, v15
    v_add_f32 v100, v100, v16
    v_add_f32 v101, v101, v17
    v_add_f32 v102, v102, v18
    v_add_f32 v103, v103, v19
    v_add_f32 v96, s93, v96
    s_waitcnt lgkmcnt(4)
    v_mfma_f32_32x32x16_bf16 v[112:127], a[56:59], v[36:39], v[112:127]
    ds_read_b128 v[32:35], v11 offset:16384
    v_add_f32 v97, s93, v97
    v_add_f32 v98, s93, v98
    v_add_f32 v99, s93, v99
    v_add_f32 v100, s93, v100
    v_add_f32 v101, s93, v101
    v_add_f32 v102, s93, v102
    v_add_f32 v103, s93, v103
    s_waitcnt lgkmcnt(4)
    v_mfma_f32_32x32x16_bf16 v[112:127], a[60:63], v[40:43], v[112:127]
    ds_read_b128 v[36:39], v8 offset:20480
    v_cvt_pk_bf16_f32 v96, v96, v97
    v_cvt_pk_bf16_f32 v97, v98, v99
    v_cvt_pk_bf16_f32 v98, v100, v101
    v_cvt_pk_bf16_f32 v99, v102, v103
    s_add_u32 s96, s8, 4
    s_and_b32 s96, s96, 63
    s_mul_i32 s96, s96, 147456
    s_add_u32 s96, s96, s90
    buffer_store_dwordx4 v[96:99], v6, s[52:55], s96 offen sc1
    s_nop 0
    s_waitcnt lgkmcnt(4)
    v_mfma_f32_32x32x16_bf16 v[112:127], a[64:67], v[20:23], v[112:127]
    ds_read_b128 v[40:43], v9 offset:20480
    v_mul_f32 v12, s91, v104
    v_mul_f32 v13, s91, v105
    v_mul_f32 v14, s91, v106
    v_mul_f32 v15, s91, v107
    v_mul_f32 v16, s91, v108
    v_mul_f32 v17, s91, v109
    v_mul_f32 v18, s91, v110
    s_waitcnt lgkmcnt(4)
    v_mfma_f32_32x32x16_bf16 v[112:127], a[68:71], v[24:27], v[112:127]
    ds_read_b128 v[20:23], v10 offset:20480
    v_mul_f32 v19, s91, v111
    v_exp_f32_e64 v12, v12 clamp
    v_exp_f32_e64 v13, v13 clamp
    v_exp_f32_e64 v14, v14 clamp
    s_waitcnt lgkmcnt(4)
    v_mfma_f32_32x32x16_bf16 v[112:127], a[72:75], v[28:31], v[112:127]
    ds_read_b128 v[24:27], v11 offset:20480
    v_exp_f32_e64 v15, v15 clamp
    v_exp_f32_e64 v16, v16 clamp
    v_exp_f32_e64 v17, v17 clamp
    s_waitcnt lgkmcnt(4)
    v_mfma_f32_32x32x16_bf16 v[112:127], a[76:79], v[32:35], v[112:127]
    ds_read_b128 v[28:31], v8 offset:24576
    v_exp_f32_e64 v18, v18 clamp
    v_exp_f32_e64 v19, v19 clamp
    v_max_f32 v104, 0, v104
    v_max_f32 v105, 0, v105
    v_max_f32 v106, 0, v106
    s_waitcnt lgkmcnt(4)
    v_mfma_f32_32x32x16_bf16 v[112:127], a[80:83], v[36:39], v[112:127]
    ds_read_b128 v[32:35], v9 offset:24576
    v_max_f32 v107, 0, v107
    v_max_f32 v108, 0, v108
    v_max_f32 v109, 0, v109
    v_max_f32 v110, 0, v110
    v_max_f32 v111, 0, v111
    v_add_f32 v104, v104, v12
    v_add_f32 v105, v105, v13
    s_waitcnt lgkmcnt(4)
    v_mfma_f32_32x32x16_bf16 v[112:127], a[84:87], v[40:43], v[112:127]
    ds_read_b128 v[36:39], v10 offset:24576
    v_add_f32 v106, v106, v14
    v_add_f32 v107, v107, v15
    v_add_f32 v108, v108, v16
    v_add_f32 v109, v109, v17
    v_add_f32 v110, v110, v18
    v_add_f32 v111, v111, v19
    v_add_f32 v104, s93, v104
    s_waitcnt lgkmcnt(4)
    v_mfma_f32_32x32x16_bf16 v[112:127], a[88:91], v[20:23], v[112:127]
    ds_read_b128 v[40:43], v11 offset:24576
    v_add_f32 v105, s93, v105
    v_add_f32 v106, s93, v106
    v_add_f32 v107, s93, v107
    v_add_f32 v108, s93, v108
    v_add_f32 v109, s93, v109
    v_add_f32 v110, s93, v110
    v_add_f32 v111, s93, v111
    s_waitcnt lgkmcnt(4)
    v_mfma_f32_32x32x16_bf16 v[112:127], a[92:95], v[24:27], v[112:127]
    ds_read_b128 v[20:23], v8 offset:28672
    v_cvt_pk_bf16_f32 v104, v104, v105
    v_cvt_pk_bf16_f32 v105, v106, v107
    v_cvt_pk_bf16_f32 v106, v108, v109
    v_cvt_pk_bf16_f32 v107, v110, v111
    s_add_u32 s96, s8, 4
    s_and_b32 s96, s96, 63
    s_mul_i32 s96, s96, 147456
    s_add_u32 s96, s96, s90
    s_add_u32 s96, s96, 4096
    buffer_store_dwordx4 v[104:107], v6, s[52:55], s96 offen sc1
    s_nop 0
    s_waitcnt lgkmcnt(4)
    v_mfma_f32_32x32x16_bf16 v[112:127], a[96:99], v[28:31], v[112:127]
    ds_read_b128 v[24:27], v9 offset:28672
    s_waitcnt lgkmcnt(4)
    v_mfma_f32_32x32x16_bf16 v[112:127], a[100:103], v[32:35], v[112:127]
    ds_read_b128 v[28:31], v10 offset:28672
    s_waitcnt lgkmcnt(4)
    v_mfma_f32_32x32x16_bf16 v[112:127], a[104:107], v[36:39], v[112:127]
    ds_read_b128 v[32:35], v11 offset:28672
    s_waitcnt vmcnt(5) lgkmcnt(0)
    s_barrier
    v_add_u32 v8, s36, v8
    v_add_u32 v9, s36, v9
    v_add_u32 v10, s36, v10
    v_add_u32 v11, s36, v11
    v_mfma_f32_32x32x16_bf16 v[112:127], a[108:111], v[40:43], v[112:127]
    ds_read_b128 v[36:39], v8 offset:0
    s_add_u32 m0, s88, 0
    s_add_u32 s96, s10, 327680
    s_and_b32 s96, s96, 0x1fffff
    s_add_u32 s96, s96, s30
    buffer_load_dwordx4 v4, s[40:43], s96 offen lds
    v_mfma_f32_32x32x16_bf16 v[112:127], a[112:115], v[20:23], v[112:127]
    ds_read_b128 v[40:43], v9 offset:0
    s_add_u32 m0, s88, 8192
    s_add_u32 s96, s10, 327680
    s_and_b32 s96, s96, 0x1fffff
    s_add_u32 s96, s96, s31
    buffer_load_dwordx4 v4, s[40:43], s96 offen lds
    v_mfma_f32_32x32x16_bf16 v[112:127], a[116:119], v[24:27], v[112:127]
    ds_read_b128 v[20:23], v10 offset:0
    s_add_u32 m0, s88, 16384
    s_add_u32 s96, s10, 327680
    s_and_b32 s96, s96, 0x1fffff
    s_add_u32 s96, s96, s32
    buffer_load_dwordx4 v4, s[40:43], s96 offen lds
    v_mfma_f32_32x32x16_bf16 v[112:127], a[120:123], v[28:31], v[112:127]
    ds_read_b128 v[24:27], v11 offset:0
    s_add_u32 m0, s88, 24576
    s_add_u32 s96, s10, 327680
    s_and_b32 s96, s96, 0x1fffff
    s_add_u32 s96, s96, s33
    buffer_load_dwordx4 v4, s[40:43], s96 offen lds
    v_mfma_f32_32x32x16_bf16 v[112:127], a[124:127], v[32:35], v[112:127]
    ds_read_b128 v[28:31], v8 offset:4096
    s_waitcnt lgkmcnt(4)
    v_mfma_f32_32x32x16_bf16 v[64:79], a[0:3], v[36:39], 0
    ds_read_b128 v[32:35], v9 offset:4096
    s_nop 8
    v_mul_f32 v12, s91, v112
    v_mul_f32 v13, s91, v113
    v_mul_f32 v14, s91, v114
    v_mul_f32 v15, s91, v115
    v_mul_f32 v16, s91, v116
    v_mul_f32 v17, s91, v117
    v_mul_f32 v18, s91, v118
    s_waitcnt lgkmcnt(4)
    v_mfma_f32_32x32x16_bf16 v[64:79], a[4:7], v[40:43], v[64:79]
    ds_read_b128 v[36:39], v10 offset:4096
    v_mul_f32 v19, s91, v119
    v_exp_f32_e64 v12, v12 clamp
    v_exp_f32_e64 v13, v13 clamp
    v_exp_f32_e64 v14, v14 clamp
    s_waitcnt lgkmcnt(4)
    v_mfma_f32_32x32x16_bf16 v[64:79], a[8:11], v[20:23], v[64:79]
    ds_read_b128 v[40:43], v11 offset:4096
    v_exp_f32_e64 v15, v15 clamp
    v_exp_f32_e64 v16, v16 clamp
    v_exp_f32_e64 v17, v17 clamp
    s_waitcnt lgkmcnt(4)
    v_mfma_f32_32x32x16_bf16 v[64:79], a[12:15], v[24:27], v[64:79]
    ds_read_b128 v[20:23], v8 offset:8192
    v_exp_f32_e64 v18, v18 clamp
    v_exp_f32_e64 v19, v19 clamp
    v_max_f32 v112, 0, v112
    v_max_f32 v113, 0, v113
    v_max_f32 v114, 0, v114
    s_waitcnt lgkmcnt(4)
    v_mfma_f32_32x32x16_bf16 v[64:79], a[16:19], v[28:31], v[64:79]
    ds_read_b128 v[24:27], v9 offset:8192
    v_max_f32 v115, 0, v115
    v_max_f32 v116, 0, v116
    v_max_f32 v117, 0, v117
    v_max_f32 v118, 0, v118
    v_max_f32 v119, 0, v119
    v_add_f32 v112, v112, v12
    v_add_f32 v113, v113, v13
    s_waitcnt lgkmcnt(4)
    v_mfma_f32_32x32x16_bf16 v[64:79], a[20:23], v[32:35], v[64:79]
    ds_read_b128 v[28:31], v10 offset:8192
    v_add_f32 v114, v114, v14
    v_add_f32 v115, v115, v15
    v_add_f32 v116, v116, v16
    v_add_f32 v117, v117, v17
    v_add_f32 v118, v118, v18
    v_add_f32 v119, v119, v19
    v_add_f32 v112, s93, v112
    s_waitcnt lgkmcnt(4)
    v_mfma_f32_32x32x16_bf16 v[64:79], a[24:27], v[36:39], v[64:79]
    ds_read_b128 v[32:35], v11 offset:8192
    v_add_f32 v113, s93, v113
    v_add_f32 v114, s93, v114
    v_add_f32 v115, s93, v115
    v_add_f32 v116, s93, v116
    v_add_f32 v117, s93, v117
    v_add_f32 v118, s93, v118
    v_add_f32 v119, s93, v119
    s_waitcnt lgkmcnt(4)
    v_mfma_f32_32x32x16_bf16 v[64:79], a[28:31], v[40:43], v[64:79]
    ds_read_b128 v[36:39], v8 offset:12288
    v_cvt_pk_bf16_f32 v112, v112, v113
    v_cvt_pk_bf16_f32 v113, v114, v115
    v_cvt_pk_bf16_f32 v114, v116, v117
    v_cvt_pk_bf16_f32 v115, v118, v119
    s_add_u32 s96, s8, 6
    s_and_b32 s96, s96, 63
    s_mul_i32 s96, s96, 147456
    s_add_u32 s96, s96, s90
    buffer_store_dwordx4 v[112:115], v6, s[52:55], s96 offen sc1
    s_nop 0
    s_waitcnt lgkmcnt(4)
    v_mfma_f32_32x32x16_bf16 v[64:79], a[32:35], v[20:23], v[64:79]
    ds_read_b128 v[40:43], v9 offset:12288
    v_mul_f32 v12, s91, v120
    v_mul_f32 v13, s91, v121
    v_mul_f32 v14, s91, v122
    v_mul_f32 v15, s91, v123
    v_mul_f32 v16, s91, v124
    v_mul_f32 v17, s91, v125
    v_mul_f32 v18, s91, v126
    s_waitcnt lgkmcnt(4)
    v_mfma_f32_32x32x16_bf16 v[64:79], a[36:39], v[24:27], v[64:79]
    ds_read_b128 v[20:23], v10 offset:12288
    v_mul_f32 v19, s91, v127
    v_exp_f32_e64 v12, v12 clamp
    v_exp_f32_e64 v13, v13 clamp
    v_exp_f32_e64 v14, v14 clamp
    s_waitcnt lgkmcnt(4)
    v_mfma_f32_32x32x16_bf16 v[64:79], a[40:43], v[28:31], v[64:79]
    ds_read_b128 v[24:27], v11 offset:12288
    v_exp_f32_e64 v15, v15 clamp
    v_exp_f32_e64 v16, v16 clamp
    v_exp_f32_e64 v17, v17 clamp
    s_waitcnt lgkmcnt(4)
    v_mfma_f32_32x32x16_bf16 v[64:79], a[44:47], v[32:35], v[64:79]
    ds_read_b128 v[28:31], v8 offset:16384
    v_exp_f32_e64 v18, v18 clamp
    v_exp_f32_e64 v19, v19 clamp
    v_max_f32 v120, 0, v120
    v_max_f32 v121, 0, v121
    v_max_f32 v122, 0, v122
    s_waitcnt lgkmcnt(4)
    v_mfma_f32_32x32x16_bf16 v[64:79], a[48:51], v[36:39], v[64:79]
    ds_read_b128 v[32:35], v9 offset:16384
    v_max_f32 v123, 0, v123
    v_max_f32 v124, 0, v124
    v_max_f32 v125, 0, v125
    v_max_f32 v126, 0, v126
    v_max_f32 v127, 0, v127
    v_add_f32 v120, v120, v12
    v_add_f32 v121, v121, v13
    s_waitcnt lgkmcnt(4)
    v_mfma_f32_32x32x16_bf16 v[64:79], a[52:55], v[40:43], v[64:79]
    ds_read_b128 v[36:39], v10 offset:16384
    v_add_f32 v122, v122, v14
    v_add_f32 v123, v123, v15
    v_add_f32 v124, v124, v16
    v_add_f32 v125, v125, v17
    v_add_f32 v126, v126, v18
    v_add_f32 v127, v127, v19
    v_add_f32 v120, s93, v120
    s_waitcnt lgkmcnt(4)
    v_mfma_f32_32x32x16_bf16 v[64:79], a[56:59], v[20:23], v[64:79]
    ds_read_b128 v[40:43], v11 offset:16384
    v_add_f32 v121, s93, v121
    v_add_f32 v122, s93, v122
    v_add_f32 v123, s93, v123
    v_add_f32 v124, s93, v124
    v_add_f32 v125, s93, v125
    v_add_f32 v126, s93, v126
    v_add_f32 v127, s93, v127
    s_waitcnt lgkmcnt(4)
    v_mfma_f32_32x32x16_bf16 v[64:79], a[60:63], v[24:27], v[64:79]
    ds_read_b128 v[20:23], v8 offset:20480
    v_cvt_pk_bf16_f32 v120, v120, v121
    v_cvt_pk_bf16_f32 v121, v122, v123
    v_cvt_pk_bf16_f32 v122, v124, v125
    v_cvt_pk_bf16_f32 v123, v126, v127
    s_add_u32 s96, s8, 6
    s_and_b32 s96, s96, 63
    s_mul_i32 s96, s96, 147456
    s_add_u32 s96, s96, s90
    s_add_u32 s96, s96, 4096
    buffer_store_dwordx4 v[120:123], v6, s[52:55], s96 offen sc1
    s_nop 0
    s_waitcnt lgkmcnt(4)
    v_mfma_f32_32x32x16_bf16 v[64:79], a[64:67], v[28:31], v[64:79]
    ds_read_b128 v[24:27], v9 offset:20480
    s_waitcnt lgkmcnt(4)
    v_mfma_f32_32x32x16_bf16 v[64:79], a[68:71], v[32:35], v[64:79]
    ds_read_b128 v[28:31], v10 offset:20480
    s_waitcnt lgkmcnt(4)
    v_mfma_f32_32x32x16_bf16 v[64:79], a[72:75], v[36:39], v[64:79]
    ds_read_b128 v[32:35], v11 offset:20480
    s_waitcnt lgkmcnt(4)
    v_mfma_f32_32x32x16_bf16 v[64:79], a[76:79], v[40:43], v[64:79]
    ds_read_b128 v[36:39], v8 offset:24576
    s_waitcnt lgkmcnt(4)
    v_mfma_f32_32x32x16_bf16 v[64:79], a[80:83], v[20:23], v[64:79]
    ds_read_b128 v[40:43], v9 offset:24576
    s_waitcnt lgkmcnt(4)
    v_mfma_f32_32x32x16_bf16 v[64:79], a[84:87], v[24:27], v[64:79]
    ds_read_b128 v[20:23], v10 offset:24576
    s_waitcnt lgkmcnt(4)
    v_mfma_f32_32x32x16_bf16 v[64:79], a[88:91], v[28:31], v[64:79]
    ds_read_b128 v[24:27], v11 offset:24576
    s_waitcnt lgkmcnt(4)
    v_mfma_f32_32x32x16_bf16 v[64:79], a[92:95], v[32:35], v[64:79]
    ds_read_b128 v[28:31], v8 offset:28672
    s_waitcnt lgkmcnt(4)
    v_mfma_f32_32x32x16_bf16 v[64:79], a[96:99], v[36:39], v[64:79]
    ds_read_b128 v[32:35], v9 offset:28672
    s_waitcnt lgkmcnt(4)
    v_mfma_f32_32x32x16_bf16 v[64:79], a[100:103], v[40:43], v[64:79]
    ds_read_b128 v[36:39], v10 offset:28672
    s_waitcnt lgkmcnt(4)
    v_mfma_f32_32x32x16_bf16 v[64:79], a[104:107], v[20:23], v[64:79]
    ds_read_b128 v[40:43], v11 offset:28672
    s_waitcnt vmcnt(2) lgkmcnt(0)
    s_barrier
    v_add_u32 v8, s37, v8
    v_add_u32 v9, s37, v9
    v_add_u32 v10, s37, v10
    v_add_u32 v11, s37, v11
    v_mfma_f32_32x32x16_bf16 v[64:79], a[108:111], v[24:27], v[64:79]
    ds_read_b128 v[20:23], v8 offset:0
    v_mfma_f32_32x32x16_bf16 v[64:79], a[112:115], v[28:31], v[64:79]
    ds_read_b128 v[24:27], v9 offset:0
    v_mfma_f32_32x32x16_bf16 v[64:79], a[116:119], v[32:35], v[64:79]
    ds_read_b128 v[28:31], v10 offset:0
    v_mfma_f32_32x32x16_bf16 v[64:79], a[120:123], v[36:39], v[64:79]
    ds_read_b128 v[32:35], v11 offset:0
    v_mfma_f32_32x32x16_bf16 v[64:79], a[124:127], v[40:43], v[64:79]
    ds_read_b128 v[36:39], v8 offset:4096
    s_lshr_b32 s12, s97, 2
    s_or_b32 s12, s12, s100
    s_cmp_eq_u32 s12, 0
    s_cbranch_scc1 K1_q_last
    s_nop 7
    v_mul_f32 v12, s91, v64
    v_mul_f32 v13, s91, v65
    v_mul_f32 v14, s91, v66
    v_mul_f32 v15, s91, v67
    v_mul_f32 v16, s91, v68
    v_mul_f32 v17, s91, v69
    v_mul_f32 v18, s91, v70
    v_mul_f32 v19, s91, v71
    v_exp_f32_e64 v12, v12 clamp
    v_exp_f32_e64 v13, v13 clamp
    v_exp_f32_e64 v14, v14 clamp
    v_exp_f32_e64 v15, v15 clamp
    v_exp_f32_e64 v16, v16 clamp
    v_exp_f32_e64 v17, v17 clamp
    v_exp_f32_e64 v18, v18 clamp
    v_exp_f32_e64 v19, v19 clamp
    v_max_f32 v64, 0, v64
    v_max_f32 v65, 0, v65
    v_max_f32 v66, 0, v66
    v_max_f32 v67, 0, v67
    v_max_f32 v68, 0, v68
    v_max_f32 v69, 0, v69
    v_max_f32 v70, 0, v70
    v_max_f32 v71, 0, v71
    v_add_f32 v64, v64, v12
    v_add_f32 v65, v65, v13
    v_add_f32 v66, v66, v14
    v_add_f32 v67, v67, v15
    v_add_f32 v68, v68, v16
    v_add_f32 v69, v69, v17
    v_add_f32 v70, v70, v18
    v_add_f32 v71, v71, v19
    v_add_f32 v64, s93, v64
    v_add_f32 v65, s93, v65
    v_add_f32 v66, s93, v66
    v_add_f32 v67, s93, v67
    v_add_f32 v68, s93, v68
    v_add_f32 v69, s93, v69
    v_add_f32 v70, s93, v70
    v_add_f32 v71, s93, v71
    v_cvt_pk_bf16_f32 v64, v64, v65
    v_cvt_pk_bf16_f32 v65, v66, v67
    v_cvt_pk_bf16_f32 v66, v68, v69
    v_cvt_pk_bf16_f32 v67, v70, v71
    s_add_u32 s96, s8, 8
    s_and_b32 s96, s96, 63
    s_mul_i32 s96, s96, 147456
    s_add_u32 s96, s96, s90
    buffer_store_dwordx4 v[64:67], v6, s[52:55], s96 offen sc1
    s_nop 0
    v_mul_f32 v12, s91, v72
    v_mul_f32 v13, s91, v73
    v_mul_f32 v14, s91, v74
    v_mul_f32 v15, s91, v75
    v_mul_f32 v16, s91, v76
    v_mul_f32 v17, s91, v77
    v_mul_f32 v18, s91, v78
    v_mul_f32 v19, s91, v79
    v_exp_f32_e64 v12, v12 clamp
    v_exp_f32_e64 v13, v13 clamp
    v_exp_f32_e64 v14, v14 clamp
    v_exp_f32_e64 v15, v15 clamp
    v_exp_f32_e64 v16, v16 clamp
    v_exp_f32_e64 v17, v17 clamp
    v_exp_f32_e64 v18, v18 clamp
    v_exp_f32_e64 v19, v19 clamp
    v_max_f32 v72, 0, v72
    v_max_f32 v73, 0, v73
    v_max_f32 v74, 0, v74
    v_max_f32 v75, 0, v75
    v_max_f32 v76, 0, v76
    v_max_f32 v77, 0, v77
    v_max_f32 v78, 0, v78
    v_max_f32 v79, 0, v79
    v_add_f32 v72, v72, v12
    v_add_f32 v73, v73, v13
    v_add_f32 v74, v74, v14
    v_add_f32 v75, v75, v15
    v_add_f32 v76, v76, v16
    v_add_f32 v77, v77, v17
    v_add_f32 v78, v78, v18
    v_add_f32 v79, v79, v19
    v_add_f32 v72, s93, v72
    v_add_f32 v73, s93, v73
    v_add_f32 v74, s93, v74
    v_add_f32 v75, s93, v75
    v_add_f32 v76, s93, v76
    v_add_f32 v77, s93, v77
    v_add_f32 v78, s93, v78
    v_add_f32 v79, s93, v79
    v_cvt_pk_bf16_f32 v72, v72, v73
    v_cvt_pk_bf16_f32 v73, v74, v75
    v_cvt_pk_bf16_f32 v74, v76, v77
    v_cvt_pk_bf16_f32 v75, v78, v79
    s_add_u32 s96, s8, 8
    s_and_b32 s96, s96, 63
    s_mul_i32 s96, s96, 147456
    s_add_u32 s96, s96, s90
    s_add_u32 s96, s96, 4096
    buffer_store_dwordx4 v[72:75], v6, s[52:55], s96 offen sc1
    s_nop 0
    s_endpgm
K1_q_last:
    s_waitcnt lgkmcnt(4)
    v_mfma_f32_32x32x16_bf16 v[80:95], a[0:3], v[20:23], 0
    ds_read_b128 v[40:43], v9 offset:4096
    s_nop 8
    v_mul_f32 v12, s91, v64
    v_mul_f32 v13, s91, v65
    v_mul_f32 v14, s91, v66
    v_mul_f32 v15, s91, v67
    v_mul_f32 v16, s91, v68
    s_waitcnt lgkmcnt(4)
    v_mfma_f32_32x32x16_bf16 v[80:95], a[4:7], v[24:27], v[80:95]
    ds_read_b128 v[20:23], v10 offset:4096
    v_mul_f32 v17, s91, v69
    v_mul_f32 v18, s91, v70
    v_mul_f32 v19, s91, v71
    v_exp_f32_e64 v12, v12 clamp
    s_waitcnt lgkmcnt(4)
    v_mfma_f32_32x32x16_bf16 v[80:95], a[8:11], v[28:31], v[80:95]
    ds_read_b128 v[24:27], v11 offset:4096
    v_exp_f32_e64 v13, v13 clamp
    v_exp_f32_e64 v14, v14 clamp
    s_waitcnt lgkmcnt(4)
    v_mfma_f32_32x32x16_bf16 v[80:95], a[12:15], v[32:35], v[80:95]
    ds_read_b128 v[28:31], v8 offset:8192
    v_exp_f32_e64 v15, v15 clamp
    v_exp_f32_e64 v16, v16 clamp
    s_waitcnt lgkmcnt(4)
    v_mfma_f32_32x32x16_bf16 v[80:95], a[16:19], v[36:39], v[80:95]
    ds_read_b128 v[32:35], v9 offset:8192
    v_exp_f32_e64 v17, v17 clamp
    v_exp_f32_e64 v18, v18 clamp
    s_waitcnt lgkmcnt(4)
    v_mfma_f32_32x32x16_bf16 v[80:95], a[20:23], v[40:43], v[80:95]
    ds_read_b128 v[36:39], v10 offset:8192
    v_exp_f32_e64 v19, v19 clamp
    v_max_f32 v64, 0, v64
    v_max_f32 v65, 0, v65
    v_max_f32 v66, 0, v66
    s_waitcnt lgkmcnt(4)
    v_mfma_f32_32x32x16_bf16 v[80:95], a[24:27], v[20:23], v[80:95]
    ds_read_b128 v[40:43], v11 offset:8192
    v_max_f32 v67, 0, v67
    v_max_f32 v68, 0, v68
    v_max_f32 v69, 0, v69
    v_max_f32 v70, 0, v70
    v_max_f32 v71, 0, v71
    s_waitcnt lgkmcnt(4)
    v_mfma_f32_32x32x16_bf16 v[80:95], a[28:31], v[24:27], v[80:95]
    ds_read_b128 v[20:23], v8 offset:12288
    v_add_f32 v64, v64, v12
    v_add_f32 v65, v65, v13
    v_add_f32 v66, v66, v14
    v_add_f32 v67, v67, v15
    v_add_f32 v68, v68, v16
    s_waitcnt lgkmcnt(4)
    v_mfma_f32_32x32x16_bf16 v[80:95], a[32:35], v[28:31], v[80:95]
    ds_read_b128 v[24:27], v9 offset:12288
    v_add_f32 v69, v69, v17
    v_add_f32 v70, v70, v18
    v_add_f32 v71, v71, v19
    v_add_f32 v64, s93, v64
    v_add_f32 v65, s93, v65
    s_waitcnt lgkmcnt(4)
    v_mfma_f32_32x32x16_bf16 v[80:95], a[36:39], v[32:35], v[80:95]
    ds_read_b128 v[28:31], v10 offset:12288
    v_add_f32 v66, s93, v66
    v_add_f32 v67, s93, v67
    v_add_f32 v68, s93, v68
    v_add_f32 v69, s93, v69
    v_add_f32 v70, s93, v70
    s_waitcnt lgkmcnt(4)
    v_mfma_f32_32x32x16_bf16 v[80:95], a[40:43], v[36:39], v[80:95]
    ds_read_b128 v[32:35], v11 offset:12288
    v_add_f32 v71, s93, v71
    v_cvt_pk_bf16_f32 v64, v64, v65
    v_cvt_pk_bf16_f32 v65, v66, v67
    v_cvt_pk_bf16_f32 v66, v68, v69
    v_cvt_pk_bf16_f32 v67, v70, v71
    s_waitcnt lgkmcnt(4)
    v_mfma_f32_32x32x16_bf16 v[80:95], a[44:47], v[40:43], v[80:95]
    ds_read_b128 v[36:39], v8 offset:16384
    s_add_u32 s96, s8, 8
    s_and_b32 s96, s96, 63
    s_mul_i32 s96, s96, 147456
    s_add_u32 s96, s96, s90
    buffer_store_dwordx4 v[64:67], v6, s[52:55], s96 offen sc1
    s_nop 0
    v_mul_f32 v12, s91, v72
    v_mul_f32 v13, s91, v73
    s_waitcnt lgkmcnt(4)
    v_mfma_f32_32x32x16_bf16 v[80:95], a[48:51], v[20:23], v[80:95]
    ds_read_b128 v[40:43], v9 offset:16384
    v_mul_f32 v14, s91, v74
    v_mul_f32 v15, s91, v75
    v_mul_f32 v16, s91, v76
    v_mul_f32 v17, s91, v77
    v_mul_f32 v18, s91, v78
    s_waitcnt lgkmcnt(4)
    v_mfma_f32_32x32x16_bf16 v[80:95], a[52:55], v[24:27], v[80:95]
    ds_read_b128 v[20:23], v10 offset:16384
    v_mul_f32 v19, s91, v79
    v_exp_f32_e64 v12, v12 clamp
    v_exp_f32_e64 v13, v13 clamp
    s_waitcnt lgkmcnt(4)
    v_mfma_f32_32x32x16_bf16 v[80:95], a[56:59], v[28:31], v[80:95]
    ds_read_b128 v[24:27], v11 offset:16384
    v_exp_f32_e64 v14, v14 clamp
    v_exp_f32_e64 v15, v15 clamp
    s_waitcnt lgkmcnt(4)
    v_mfma_f32_32x32x16_bf16 v[80:95], a[60:63], v[32:35], v[80:95]
    ds_read_b128 v[28:31], v8 offset:20480
    v_exp_f32_e64 v16, v16 clamp
    v_exp_f32_e64 v17, v17 clamp
    s_waitcnt lgkmcnt(4)
    v_mfma_f32_32x32x16_bf16 v[80:95], a[64:67], v[36:39], v[80:95]
    ds_read_b128 v[32:35], v9 offset:20480
    v_exp_f32_e64 v18, v18 clamp
    v_exp_f32_e64 v19, v19 clamp
    v_max_f32 v72, 0, v72
    s_waitcnt lgkmcnt(4)
    v_mfma_f32_32x32x16_bf16 v[80:95], a[68:71], v[40:43], v[80:95]
    ds_read_b128 v[36:39], v10 offset:20480
    v_max_f32 v73, 0, v73
    v_max_f32 v74, 0, v74
    v_max_f32 v75, 0, v75
    v_max_f32 v76, 0, v76
    v_max_f32 v77, 0, v77
    s_waitcnt lgkmcnt(4)
    v_mfma_f32_32x32x16_bf16 v[80:95], a[72:75], v[20:23], v[80:95]
    ds_read_b128 v[40:43], v11 offset:20480
    v_max_f32 v78, 0, v78
    v_max_f32 v79, 0, v79
    v_add_f32 v72, v72, v12
    v_add_f32 v73, v73, v13
    v_add_f32 v74, v74, v14
    s_waitcnt lgkmcnt(4)
    v_mfma_f32_32x32x16_bf16 v[80:95], a[76:79], v[24:27], v[80:95]
    ds_read_b128 v[20:23], v8 offset:24576
    v_add_f32 v75, v75, v15
    v_add_f32 v76, v76, v16
    v_add_f32 v77, v77, v17
    v_add_f32 v78, v78, v18
    v_add_f32 v79, v79, v19
    s_waitcnt lgkmcnt(4)
    v_mfma_f32_32x32x16_bf16 v[80:95], a[80:83], v[28:31], v[80:95]
    ds_read_b128 v[24:27], v9 offset:24576
    v_add_f32 v72, s93, v72
    v_add_f32 v73, s93, v73
    v_add_f32 v74, s93, v74
    v_add_f32 v75, s93, v75
    v_add_f32 v76, s93, v76
    s_waitcnt lgkmcnt(4)
    v_mfma_f32_32x32x16_bf16 v[80:95], a[84:87], v[32:35], v[80:95]
    ds_read_b128 v[28:31], v10 offset:24576
    v_add_f32 v77, s93, v77
    v_add_f32 v78, s93, v78
    v_add_f32 v79, s93, v79
    v_cvt_pk_bf16_f32 v72, v72, v73
    v_cvt_pk_bf16_f32 v73, v74, v75
    s_waitcnt lgkmcnt(4)
    v_mfma_f32_32x32x16_bf16 v[80:95], a[88:91], v[36:39], v[80:95]
    ds_read_b128 v[32:35], v11 offset:24576
    v_cvt_pk_bf16_f32 v74, v76, v77
    v_cvt_pk_bf16_f32 v75, v78, v79
    s_add_u32 s96, s8, 8
    s_and_b32 s96, s96, 63
    s_mul_i32 s96, s96, 147456
    s_add_u32 s96, s96, s90
    s_add_u32 s96, s96, 4096
    buffer_store_dwordx4 v[72:75], v6, s[52:55], s96 offen sc1
    s_nop 0
    s_waitcnt lgkmcnt(4)
    v_mfma_f32_32x32x16_bf16 v[80:95], a[92:95], v[40:43], v[80:95]
    ds_read_b128 v[36:39], v8 offset:28672
    s_waitcnt lgkmcnt(4)
    v_mfma_f32_32x32x16_bf16 v[80:95], a[96:99], v[20:23], v[80:95]
    ds_read_b128 v[40:43], v9 offset:28672
    s_waitcnt lgkmcnt(4)
    v_mfma_f32_32x32x16_bf16 v[80:95], a[100:103], v[24:27], v[80:95]
    ds_read_b128 v[20:23], v10 offset:28672
    s_waitcnt lgkmcnt(4)
    v_mfma_f32_32x32x16_bf16 v[80:95], a[104:107], v[28:31], v[80:95]
    ds_read_b128 v[24:27], v11 offset:28672
    s_waitcnt lgkmcnt(4)
    v_mfma_f32_32x32x16_bf16 v[80:95], a[108:111], v[32:35], v[80:95]
    s_waitcnt lgkmcnt(3)
    v_mfma_f32_32x32x16_bf16 v[80:95], a[112:115], v[36:39], v[80:95]
    s_waitcnt lgkmcnt(2)
    v_mfma_f32_32x32x16_bf16 v[80:95], a[116:119], v[40:43], v[80:95]
    s_waitcnt lgkmcnt(1)
    v_mfma_f32_32x32x16_bf16 v[80:95], a[120:123], v[20:23], v[80:95]
    s_waitcnt lgkmcnt(0)
    v_mfma_f32_32x32x16_bf16 v[80:95], a[124:127], v[24:27], v[80:95]
    s_nop 12
    v_mul_f32 v12, s91, v80
    v_mul_f32 v13, s91, v81
    v_mul_f32 v14, s91, v82
    v_mul_f32 v15, s91, v83
    v_mul_f32 v16, s91, v84
    v_mul_f32 v17, s91, v85
    v_mul_f32 v18, s91, v86
    v_mul_f32 v19, s91, v87
    v_exp_f32_e64 v12, v12 clamp
    v_exp_f32_e64 v13, v13 clamp
    v_exp_f32_e64 v14, v14 clamp
    v_exp_f32_e64 v15, v15 clamp
    v_exp_f32_e64 v16, v16 clamp
    v_exp_f32_e64 v17, v17 clamp
    v_exp_f32_e64 v18, v18 clamp
    v_exp_f32_e64 v19, v19 clamp
    v_max_f32 v80, 0, v80
    v_max_f32 v81, 0, v81
    v_max_f32 v82, 0, v82
    v_max_f32 v83, 0, v83
    v_max_f32 v84, 0, v84
    v_max_f32 v85, 0, v85
    v_max_f32 v86, 0, v86
    v_max_f32 v87, 0, v87
    v_add_f32 v80, v80, v12
    v_add_f32 v81, v81, v13
    v_add_f32 v82, v82, v14
    v_add_f32 v83, v83, v15
    v_add_f32 v84, v84, v16
    v_add_f32 v85, v85, v17
    v_add_f32 v86, v86, v18
    v_add_f32 v87, v87, v19
    v_add_f32 v80, s93, v80
    v_add_f32 v81, s93, v81
    v_add_f32 v82, s93, v82
    v_add_f32 v83, s93, v83
    v_add_f32 v84, s93, v84
    v_add_f32 v85, s93, v85
    v_add_f32 v86, s93, v86
    v_add_f32 v87, s93, v87
    v_cvt_pk_bf16_f32 v80, v80, v81
    v_cvt_pk_bf16_f32 v81, v82, v83
    v_cvt_pk_bf16_f32 v82, v84, v85
    v_cvt_pk_bf16_f32 v83, v86, v87
    s_add_u32 s96, s8, 10
    s_and_b32 s96, s96, 63
    s_mul_i32 s96, s96, 147456
    s_add_u32 s96, s96, s90
    buffer_store_dwordx4 v[80:83], v6, s[52:55], s96 offen sc1
    s_nop 0
    v_mul_f32 v12, s91, v88
    v_mul_f32 v13, s91, v89
    v_mul_f32 v14, s91, v90
    v_mul_f32 v15, s91, v91
    v_mul_f32 v16, s91, v92
    v_mul_f32 v17, s91, v93
    v_mul_f32 v18, s91, v94
    v_mul_f32 v19, s91, v95
    v_exp_f32_e64 v12, v12 clamp
    v_exp_f32_e64 v13, v13 clamp
    v_exp_f32_e64 v14, v14 clamp
    v_exp_f32_e64 v15, v15 clamp
    v_exp_f32_e64 v16, v16 clamp
    v_exp_f32_e64 v17, v17 clamp
    v_exp_f32_e64 v18, v18 clamp
    v_exp_f32_e64 v19, v19 clamp
    v_max_f32 v88, 0, v88
    v_max_f32 v89, 0, v89
    v_max_f32 v90, 0, v90
    v_max_f32 v91, 0, v91
    v_max_f32 v92, 0, v92
    v_max_f32 v93, 0, v93
    v_max_f32 v94, 0, v94
    v_max_f32 v95, 0, v95
    v_add_f32 v88, v88, v12
    v_add_f32 v89, v89, v13
    v_add_f32 v90, v90, v14
    v_add_f32 v91, v91, v15
    v_add_f32 v92, v92, v16
    v_add_f32 v93, v93, v17
    v_add_f32 v94, v94, v18
    v_add_f32 v95, v95, v19
    v_add_f32 v88, s93, v88
    v_add_f32 v89, s93, v89
    v_add_f32 v90, s93, v90
    v_add_f32 v91, s93, v91
    v_add_f32 v92, s93, v92
    v_add_f32 v93, s93, v93
    v_add_f32 v94, s93, v94
    v_add_f32 v95, s93, v95
    v_cvt_pk_bf16_f32 v88, v88, v89
    v_cvt_pk_bf16_f32 v89, v90, v91
    v_cvt_pk_bf16_f32 v90, v92, v93
    v_cvt_pk_bf16_f32 v91, v94, v95
    s_add_u32 s96, s8, 10
    s_and_b32 s96, s96, 63
    s_mul_i32 s96, s96, 147456
    s_add_u32 s96, s96, s90
    s_add_u32 s96, s96, 4096
    buffer_store_dwordx4 v[88:91], v6, s[52:55], s96 offen sc1
    s_nop 0
    s_endpgm
.p2align 6
K1_kv:
    s_lshl_b32 s12, s4, 2
    s_add_u32 s12, s12, s101
    s_lshl_b32 s11, s12, 2
    s_mul_i32 s90, s12, 1152
    s_add_u32 s90, s90, 9437184
    s_or_b32 s12, s97, s100
    s_cmp_lg_u32 s12, 0
    s_cbranch_scc1 K1_kv_nozero
    v_lshlrev_b32 v12, 3, v1
    v_mov_b32 v48, 0
    v_mov_b32 v49, 0
    v_mov_b32 v50, 0
    v_mov_b32 v51, 0
    v_mov_b32 v52, 0
    v_mov_b32 v53, 0
    buffer_atomic_swap_x2 v[48:49], v12, s[52:55], s90 offen sc0
    buffer_atomic_swap_x2 v[50:51], v12, s[52:55], s90 offen offset:512 sc0
    s_mov_b64 exec, 0xffff
    buffer_atomic_swap_x2 v[52:53], v12, s[52:55], s90 offen offset:1024 sc0
    s_mov_b64 exec, -1
K1_kv_nozero:
    s_waitcnt vmcnt(8)
    s_barrier
    ds_read_b64_tr_b16 a[0:1], v5 offset:0
    ds_read_b64_tr_b16 a[2:3], v5 offset:512
    ds_read_b128 v[20:23], v8 offset:16384
    ds_read_b128 v[24:27], v8 offset:24576
    s_waitcnt lgkmcnt(1)
    v_mfma_f32_32x32x16_bf16 v[64:79], v[20:23], a[0:3], 0
    ds_read_b64_tr_b16 a[4:5], v5 offset:2048
    ds_read_b64_tr_b16 a[6:7], v5 offset:2560
    s_waitcnt lgkmcnt(2)
    v_mfma_f32_32x32x16_bf16 v[80:95], v[24:27], a[0:3], 0
    ds_read_b128 v[32:35], v9 offset:16384
    ds_read_b128 v[36:39], v9 offset:24576
    s_waitcnt lgkmcnt(1)
    v_mfma_f32_32x32x16_bf16 v[64:79], v[32:35], a[4:7], v[64:79]
    ds_read_b64_tr_b16 a[8:9], v5 offset:4096
    ds_read_b64_tr_b16 a[10:11], v5 offset:4608
    s_waitcnt lgkmcnt(2)
    v_mfma_f32_32x32x16_bf16 v[80:95], v[36:39], a[4:7], v[80:95]
    ds_read_b128 v[20:23], v10 offset:16384
    ds_read_b128 v[24:27], v10 offset:24576
    s_waitcnt lgkmcnt(1)
    v_mfma_f32_32x32x16_bf16 v[64:79], v[20:23], a[8:11], v[64:79]
    ds_read_b64_tr_b16 a[12:13], v5 offset:6144
    ds_read_b64_tr_b16 a[14:15], v5 offset:6656
    s_waitcnt lgkmcnt(2)
    v_mfma_f32_32x32x16_bf16 v[80:95], v[24:27], a[8:11], v[80:95]
    ds_read_b128 v[32:35], v11 offset:16384
    ds_read_b128 v[36:39], v11 offset:24576
    s_waitcnt lgkmcnt(0)
    s_waitcnt vmcnt(4)
    s_barrier
    v_add_u32 v5, 0xa000, v5
    v_add_u32 v8, 0xa000, v8
    v_add_u32 v9, 0xa000, v9
    v_add_u32 v10, 0xa000, v10
    v_add_u32 v11, 0xa000, v11
    v_mfma_f32_32x32x16_bf16 v[64:79], v[32:35], a[12:15], v[64:79]
    ds_read_b64_tr_b16 a[16:17], v5 offset:0
    ds_read_b64_tr_b16 a[18:19], v5 offset:512
    s_add_u32 m0, s89, 0
    s_nop 0
    buffer_load_dwordx4 v2, s[44:47], s83 offen lds
    v_mfma_f32_32x32x16_bf16 v[80:95], v[36:39], a[12:15], v[80:95]
    ds_read_b128 v[20:23], v8 offset:16384
    ds_read_b128 v[24:27], v8 offset:24576
    s_add_u32 m0, s89, 8192
    s_nop 0
    buffer_load_dwordx4 v3, s[48:51], s83 offen lds
    s_waitcnt lgkmcnt(1)
    v_mfma_f32_32x32x16_bf16 v[64:79], v[20:23], a[16:19], v[64:79]
    ds_read_b64_tr_b16 a[20:21], v5 offset:2048
    ds_read_b64_tr_b16 a[22:23], v5 offset:2560
    s_add_u32 m0, s88, 16384
    s_add_u32 s96, s9, 0
    s_and_b32 s96, s96, 0x1fffff
    s_add_u32 s96, s96, s75
    buffer_load_dwordx4 v4, s[40:43], s96 offen lds
    s_waitcnt lgkmcnt(2)
    v_mfma_f32_32x32x16_bf16 v[80:95], v[24:27], a[16:19], v[80:95]
    ds_read_b128 v[32:35], v9 offset:16384
    ds_read_b128 v[36:39], v9 offset:24576
    s_add_u32 m0, s88, 24576
    s_add_u32 s96, s9, 65536
    s_and_b32 s96, s96, 0x1fffff
    s_add_u32 s96, s96, s75
    buffer_load_dwordx4 v4, s[40:43], s96 offen lds
    s_waitcnt lgkmcnt(1)
    v_mfma_f32_32x32x16_bf16 v[64:79], v[32:35], a[20:23], v[64:79]
    ds_read_b64_tr_b16 a[24:25], v5 offset:4096
    ds_read_b64_tr_b16 a[26:27], v5 offset:4608
    s_waitcnt lgkmcnt(2)
    v_mfma_f32_32x32x16_bf16 v[80:95], v[36:39], a[20:23], v[80:95]
    ds_read_b128 v[20:23], v10 offset:16384
    ds_read_b128 v[24:27], v10 offset:24576
    s_waitcnt lgkmcnt(1)
    v_mfma_f32_32x32x16_bf16 v[64:79], v[20:23], a[24:27], v[64:79]
    ds_read_b64_tr_b16 a[28:29], v5 offset:6144
    ds_read_b64_tr_b16 a[30:31], v5 offset:6656
    s_waitcnt lgkmcnt(2)
    v_mfma_f32_32x32x16_bf16 v[80:95], v[24:27], a[24:27], v[80:95]
    ds_read_b128 v[32:35], v11 offset:16384
    ds_read_b128 v[36:39], v11 offset:24576
    s_waitcnt lgkmcnt(0)
    s_waitcnt vmcnt(4)
    s_barrier
    v_add_u32 v5, 0xa000, v5
    v_add_u32 v8, 0xa000, v8
    v_add_u32 v9, 0xa000, v9
    v_add_u32 v10, 0xa000, v10
    v_add_u32 v11, 0xa000, v11
    v_mfma_f32_32x32x16_bf16 v[64:79], v[32:35], a[28:31], v[64:79]
    ds_read_b64_tr_b16 a[32:33], v5 offset:0
    ds_read_b64_tr_b16 a[34:35], v5 offset:512
    s_add_u32 m0, s89, 40960
    s_nop 0
    buffer_load_dwordx4 v2, s[44:47], s84 offen lds
    v_mfma_f32_32x32x16_bf16 v[80:95], v[36:39], a[28:31], v[80:95]
    ds_read_b128 v[20:23], v8 offset:16384
    ds_read_b128 v[24:27], v8 offset:24576
    s_add_u32 m0, s89, 49152
    s_nop 0
    buffer_load_dwordx4 v3, s[48:51], s84 offen lds
    s_waitcnt lgkmcnt(1)
    v_mfma_f32_32x32x16_bf16 v[64:79], v[20:23], a[32:35], v[64:79]
    ds_read_b64_tr_b16 a[36:37], v5 offset:2048
    ds_read_b64_tr_b16 a[38:39], v5 offset:2560
    s_add_u32 m0, s88, 57344
    s_add_u32 s96, s9, 0
    s_and_b32 s96, s96, 0x1fffff
    s_add_u32 s96, s96, s76
    buffer_load_dwordx4 v4, s[40:43], s96 offen lds
    s_waitcnt lgkmcnt(2)
    v_mfma_f32_32x32x16_bf16 v[80:95], v[24:27], a[32:35], v[80:95]
    ds_read_b128 v[32:35], v9 offset:16384
    ds_read_b128 v[36:39], v9 offset:24576
    s_add_u32 m0, s88, 65536
    s_add_u32 s96, s9, 65536
    s_and_b32 s96, s96, 0x1fffff
    s_add_u32 s96, s96, s76
    buffer_load_dwordx4 v4, s[40:43], s96 offen lds
    s_waitcnt lgkmcnt(1)
    v_mfma_f32_32x32x16_bf16 v[64:79], v[32:35], a[36:39], v[64:79]
    ds_read_b64_tr_b16 a[40:41], v5 offset:4096
    ds_read_b64_tr_b16 a[42:43], v5 offset:4608
    s_waitcnt lgkmcnt(2)
    v_mfma_f32_32x32x16_bf16 v[80:95], v[36:39], a[36:39], v[80:95]
    ds_read_b128 v[20:23], v10 offset:16384
    ds_read_b128 v[24:27], v10 offset:24576
    s_waitcnt lgkmcnt(1)
    v_mfma_f32_32x32x16_bf16 v[64:79], v[20:23], a[40:43], v[64:79]
    ds_read_b64_tr_b16 a[44:45], v5 offset:6144
    ds_read_b64_tr_b16 a[46:47], v5 offset:6656
    s_waitcnt lgkmcnt(2)
    v_mfma_f32_32x32x16_bf16 v[80:95], v[24:27], a[40:43], v[80:95]
    ds_read_b128 v[32:35], v11 offset:16384
    ds_read_b128 v[36:39], v11 offset:24576
    s_waitcnt lgkmcnt(0)
    s_waitcnt vmcnt(4)
    s_barrier
    s_or_b32 s12, s97, s100
    s_cmp_lg_u32 s12, 0
    s_cbranch_scc1 K1_kv_noflag
    s_mov_b64 exec, 1
    v_mov_b32 v12, 1
    v_mov_b32 v13, 0
    buffer_store_dword v12, v13, s[60:63], s11 offen sc1
    s_mov_b64 exec, -1
K1_kv_noflag:
    v_add_u32 v5, 0xfffec000, v5
    v_add_u32 v8, 0xfffec000, v8
    v_add_u32 v9, 0xfffec000, v9
    v_add_u32 v10, 0xfffec000, v10
    v_add_u32 v11, 0xfffec000, v11
    v_mfma_f32_32x32x16_bf16 v[64:79], v[32:35], a[44:47], v[64:79]
    ds_read_b64_tr_b16 a[48:49], v5 offset:0
    ds_read_b64_tr_b16 a[50:51], v5 offset:512
    s_add_u32 m0, s89, 81920
    s_nop 0
    buffer_load_dwordx4 v2, s[44:47], s85 offen lds
    v_mfma_f32_32x32x16_bf16 v[80:95], v[36:39], a[44:47], v[80:95]
    ds_read_b128 v[20:23], v8 offset:16384
    ds_read_b128 v[24:27], v8 offset:24576
    s_add_u32 m0, s89, 90112
    s_nop 0
    buffer_load_dwordx4 v3, s[48:51], s85 offen lds
    s_waitcnt lgkmcnt(1)
    v_mfma_f32_32x32x16_bf16 v[64:79], v[20:23], a[48:51], v[64:79]
    ds_read_b64_tr_b16 a[52:53], v5 offset:2048
    ds_read_b64_tr_b16 a[54:55], v5 offset:2560
    s_add_u32 m0, s88, 98304
    s_add_u32 s96, s9, 0
    s_and_b32 s96, s96, 0x1fffff
    s_add_u32 s96, s96, s77
    buffer_load_dwordx4 v4, s[40:43], s96 offen lds
    s_waitcnt lgkmcnt(2)
    v_mfma_f32_32x32x16_bf16 v[80:95], v[24:27], a[48:51], v[80:95]
    ds_read_b128 v[32:35], v9 offset:16384
    ds_read_b128 v[36:39], v9 offset:24576
    s_add_u32 m0, s88, 106496
    s_add_u32 s96, s9, 65536
    s_and_b32 s96, s96, 0x1fffff
    s_add_u32 s96, s96, s77
    buffer_load_dwordx4 v4, s[40:43], s96 offen lds
    s_waitcnt lgkmcnt(1)
    v_mfma_f32_32x32x16_bf16 v[64:79], v[32:35], a[52:55], v[64:79]
    ds_read_b64_tr_b16 a[56:57], v5 offset:4096
    ds_read_b64_tr_b16 a[58:59], v5 offset:4608
    s_waitcnt lgkmcnt(2)
    v_mfma_f32_32x32x16_bf16 v[80:95], v[36:39], a[52:55], v[80:95]
    ds_read_b128 v[20:23], v10 offset:16384
    ds_read_b128 v[24:27], v10 offset:24576
    s_waitcnt lgkmcnt(1)
    v_mfma_f32_32x32x16_bf16 v[64:79], v[20:23], a[56:59], v[64:79]
    ds_read_b64_tr_b16 a[60:61], v5 offset:6144
    ds_read_b64_tr_b16 a[62:63], v5 offset:6656
    s_waitcnt lgkmcnt(2)
    v_mfma_f32_32x32x16_bf16 v[80:95], v[24:27], a[56:59], v[80:95]
    ds_read_b128 v[32:35], v11 offset:16384
    ds_read_b128 v[36:39], v11 offset:24576
    s_waitcnt lgkmcnt(0)
    s_waitcnt vmcnt(4)
    s_barrier
    v_add_u32 v5, 0xa000, v5
    v_add_u32 v8, 0xa000, v8
    v_add_u32 v9, 0xa000, v9
    v_add_u32 v10, 0xa000, v10
    v_add_u32 v11, 0xa000, v11
    v_mfma_f32_32x32x16_bf16 v[64:79], v[32:35], a[60:63], v[64:79]
    ds_read_b64_tr_b16 a[64:65], v5 offset:0
    ds_read_b64_tr_b16 a[66:67], v5 offset:512
    s_add_u32 m0, s89, 0
    s_nop 0
    buffer_load_dwordx4 v2, s[44:47], s86 offen lds
    v_mfma_f32_32x32x16_bf16 v[80:95], v[36:39], a[60:63], v[80:95]
    ds_read_b128 v[20:23], v8 offset:16384
    ds_read_b128 v[24:27], v8 offset:24576
    s_add_u32 m0, s89, 8192
    s_nop 0
    buffer_load_dwordx4 v3, s[48:51], s86 offen lds
    s_waitcnt lgkmcnt(1)
    v_mfma_f32_32x32x16_bf16 v[64:79], v[20:23], a[64:67], v[64:79]
    ds_read_b64_tr_b16 a[68:69], v5 offset:2048
    ds_read_b64_tr_b16 a[70:71], v5 offset:2560
    s_add_u32 m0, s88, 16384
    s_add_u32 s96, s9, 0
    s_and_b32 s96, s96, 0x1fffff
    s_add_u32 s96, s96, s78
    buffer_load_dwordx4 v4, s[40:43], s96 offen lds
    s_waitcnt lgkmcnt(2)
    v_mfma_f32_32x32x16_bf16 v[80:95], v[24:27], a[64:67], v[80:95]
    ds_read_b128 v[32:35], v9 offset:16384
    ds_read_b128 v[36:39], v9 offset:24576
    s_add_u32 m0, s88, 24576
    s_add_u32 s96, s9, 65536
    s_and_b32 s96, s96, 0x1fffff
    s_add_u32 s96, s96, s78
    buffer_load_dwordx4 v4, s[40:43], s96 offen lds
    s_waitcnt lgkmcnt(1)
    v_mfma_f32_32x32x16_bf16 v[64:79], v[32:35], a[68:71], v[64:79]
    ds_read_b64_tr_b16 a[72:73], v5 offset:4096
    ds_read_b64_tr_b16 a[74:75], v5 offset:4608
    s_waitcnt lgkmcnt(2)
    v_mfma_f32_32x32x16_bf16 v[80:95], v[36:39], a[68:71], v[80:95]
    ds_read_b128 v[20:23], v10 offset:16384
    ds_read_b128 v[24:27], v10 offset:24576
    s_waitcnt lgkmcnt(1)
    v_mfma_f32_32x32x16_bf16 v[64:79], v[20:23], a[72:75], v[64:79]
    ds_read_b64_tr_b16 a[76:77], v5 offset:6144
    ds_read_b64_tr_b16 a[78:79], v5 offset:6656
    s_waitcnt lgkmcnt(2)
    v_mfma_f32_32x32x16_bf16 v[80:95], v[24:27], a[72:75], v[80:95]
    ds_read_b128 v[32:35], v11 offset:16384
    ds_read_b128 v[36:39], v11 offset:24576
    s_waitcnt lgkmcnt(0)
    s_waitcnt vmcnt(4)
    s_barrier
    v_add_u32 v5, 0xa000, v5
    v_add_u32 v8, 0xa000, v8
    v_add_u32 v9, 0xa000, v9
    v_add_u32 v10, 0xa000, v10
    v_add_u32 v11, 0xa000, v11
    v_mfma_f32_32x32x16_bf16 v[64:79], v[32:35], a[76:79], v[64:79]
    ds_read_b64_tr_b16 a[80:81], v5 offset:0
    ds_read_b64_tr_b16 a[82:83], v5 offset:512
    s_add_u32 m0, s89, 40960
    s_nop 0
    buffer_load_dwordx4 v2, s[44:47], s87 offen lds
    v_mfma_f32_32x32x16_bf16 v[80:95], v[36:39], a[76:79], v[80:95]
    ds_read_b128 v[20:23], v8 offset:16384
    ds_read_b128 v[24:27], v8 offset:24576
    s_add_u32 m0, s89, 49152
    s_nop 0
    buffer_load_dwordx4 v3, s[48:51], s87 offen lds
    s_waitcnt lgkmcnt(1)
    v_mfma_f32_32x32x16_bf16 v[64:79], v[20:23], a[80:83], v[64:79]
    ds_read_b64_tr_b16 a[84:85], v5 offset:2048
    ds_read_b64_tr_b16 a[86:87], v5 offset:2560
    s_add_u32 m0, s88, 57344
    s_add_u32 s96, s9, 0
    s_and_b32 s96, s96, 0x1fffff
    s_add_u32 s96, s96, s79
    buffer_load_dwordx4 v4, s[40:43], s96 offen lds
    s_waitcnt lgkmcnt(2)
    v_mfma_f32_32x32x16_bf16 v[80:95], v[24:27], a[80:83], v[80:95]
    ds_read_b128 v[32:35], v9 offset:16384
    ds_read_b128 v[36:39], v9 offset:24576
    s_add_u32 m0, s88, 65536
    s_add_u32 s96, s9, 65536
    s_and_b32 s96, s96, 0x1fffff
    s_add_u32 s96, s96, s79
    buffer_load_dwordx4 v4, s[40:43], s96 offen lds
    s_waitcnt lgkmcnt(1)
    v_mfma_f32_32x32x16_bf16 v[64:79], v[32:35], a[84:87], v[64:79]
    ds_read_b64_tr_b16 a[88:89], v5 offset:4096
    ds_read_b64_tr_b16 a[90:91], v5 offset:4608
    s_add_u32 m0, s88, 122880
    s_add_u32 s96, s10, 131072
    s_and_b32 s96, s96, 0x1fffff
    s_add_u32 s96, s96, s30
    buffer_load_dwordx4 v4, s[40:43], s96 offen lds
    s_waitcnt lgkmcnt(2)
    v_mfma_f32_32x32x16_bf16 v[80:95], v[36:39], a[84:87], v[80:95]
    ds_read_b128 v[20:23], v10 offset:16384
    ds_read_b128 v[24:27], v10 offset:24576
    s_add_u32 m0, s88, 131072
    s_add_u32 s96, s10, 131072
    s_and_b32 s96, s96, 0x1fffff
    s_add_u32 s96, s96, s31
    buffer_load_dwordx4 v4, s[40:43], s96 offen lds
    s_waitcnt lgkmcnt(1)
    v_mfma_f32_32x32x16_bf16 v[64:79], v[20:23], a[88:91], v[64:79]
    ds_read_b64_tr_b16 a[92:93], v5 offset:6144
    ds_read_b64_tr_b16 a[94:95], v5 offset:6656
    s_add_u32 m0, s88, 139264
    s_add_u32 s96, s10, 131072
    s_and_b32 s96, s96, 0x1fffff
    s_add_u32 s96, s96, s32
    buffer_load_dwordx4 v4, s[40:43], s96 offen lds
    s_waitcnt lgkmcnt(2)
    v_mfma_f32_32x32x16_bf16 v[80:95], v[24:27], a[88:91], v[80:95]
    ds_read_b128 v[32:35], v11 offset:16384
    ds_read_b128 v[36:39], v11 offset:24576
    s_add_u32 m0, s88, 147456
    s_add_u32 s96, s10, 131072
    s_and_b32 s96, s96, 0x1fffff
    s_add_u32 s96, s96, s33
    buffer_load_dwordx4 v4, s[40:43], s96 offen lds
    s_waitcnt lgkmcnt(0)
    s_waitcnt vmcnt(8)
    s_barrier
    v_add_u32 v5, 0xfffec000, v5
    v_add_u32 v8, 0xfffec000, v8
    v_add_u32 v9, 0xfffec000, v9
    v_add_u32 v10, 0xfffec000, v10
    v_add_u32 v11, 0xfffec000, v11
    v_mfma_f32_32x32x16_bf16 v[64:79], v[32:35], a[92:95], v[64:79]
    ds_read_b64_tr_b16 a[96:97], v5 offset:0
    ds_read_b64_tr_b16 a[98:99], v5 offset:512
    s_add_u32 m0, s88, 81920
    s_add_u32 s96, s10, 163840
    s_and_b32 s96, s96, 0x1fffff
    s_add_u32 s96, s96, s30
    buffer_load_dwordx4 v4, s[40:43], s96 offen lds
    v_mfma_f32_32x32x16_bf16 v[80:95], v[36:39], a[92:95], v[80:95]
    ds_read_b128 v[20:23], v8 offset:16384
    ds_read_b128 v[24:27], v8 offset:24576
    s_add_u32 m0, s88, 90112
    s_add_u32 s96, s10, 163840
    s_and_b32 s96, s96, 0x1fffff
    s_add_u32 s96, s96, s31
    buffer_load_dwordx4 v4, s[40:43], s96 offen lds
    s_waitcnt lgkmcnt(1)
    v_mfma_f32_32x32x16_bf16 v[64:79], v[20:23], a[96:99], v[64:79]
    ds_read_b64_tr_b16 a[100:101], v5 offset:2048
    ds_read_b64_tr_b16 a[102:103], v5 offset:2560
    s_add_u32 m0, s88, 98304
    s_add_u32 s96, s10, 163840
    s_and_b32 s96, s96, 0x1fffff
    s_add_u32 s96, s96, s32
    buffer_load_dwordx4 v4, s[40:43], s96 offen lds
    s_waitcnt lgkmcnt(2)
    v_mfma_f32_32x32x16_bf16 v[80:95], v[24:27], a[96:99], v[80:95]
    ds_read_b128 v[32:35], v9 offset:16384
    ds_read_b128 v[36:39], v9 offset:24576
    s_add_u32 m0, s88, 106496
    s_add_u32 s96, s10, 163840
    s_and_b32 s96, s96, 0x1fffff
    s_add_u32 s96, s96, s33
    buffer_load_dwordx4 v4, s[40:43], s96 offen lds
    s_waitcnt lgkmcnt(1)
    v_mfma_f32_32x32x16_bf16 v[64:79], v[32:35], a[100:103], v[64:79]
    ds_read_b64_tr_b16 a[104:105], v5 offset:4096
    ds_read_b64_tr_b16 a[106:107], v5 offset:4608
    s_waitcnt lgkmcnt(2)
    v_mfma_f32_32x32x16_bf16 v[80:95], v[36:39], a[100:103], v[80:95]
    ds_read_b128 v[20:23], v10 offset:16384
    ds_read_b128 v[24:27], v10 offset:24576
    s_waitcnt lgkmcnt(1)
    v_mfma_f32_32x32x16_bf16 v[64:79], v[20:23], a[104:107], v[64:79]
    ds_read_b64_tr_b16 a[108:109], v5 offset:6144
    ds_read_b64_tr_b16 a[110:111], v5 offset:6656
    s_waitcnt lgkmcnt(2)
    v_mfma_f32_32x32x16_bf16 v[80:95], v[24:27], a[104:107], v[80:95]
    ds_read_b128 v[32:35], v11 offset:16384
    ds_read_b128 v[36:39], v11 offset:24576
    s_waitcnt lgkmcnt(0)
    s_waitcnt vmcnt(8)
    s_barrier
    v_add_u32 v5, 0xa000, v5
    v_add_u32 v8, 0xa000, v8
    v_add_u32 v9, 0xa000, v9
    v_add_u32 v10, 0xa000, v10
    v_add_u32 v11, 0xa000, v11
    v_mfma_f32_32x32x16_bf16 v[64:79], v[32:35], a[108:111], v[64:79]
    ds_read_b64_tr_b16 a[112:113], v5 offset:0
    ds_read_b64_tr_b16 a[114:115], v5 offset:512
    s_add_u32 m0, s88, 0
    s_add_u32 s96, s10, 196608
    s_and_b32 s96, s96, 0x1fffff
    s_add_u32 s96, s96, s30
    buffer_load_dwordx4 v4, s[40:43], s96 offen lds
    v_mfma_f32_32x32x16_bf16 v[80:95], v[36:39], a[108:111], v[80:95]
    ds_read_b128 v[20:23], v8 offset:16384
    ds_read_b128 v[24:27], v8 offset:24576
    s_add_u32 m0, s88, 8192
    s_add_u32 s96, s10, 196608
    s_and_b32 s96, s96, 0x1fffff
    s_add_u32 s96, s96, s31
    buffer_load_dwordx4 v4, s[40:43], s96 offen lds
    s_waitcnt lgkmcnt(1)
    v_mfma_f32_32x32x16_bf16 v[64:79], v[20:23], a[112:115], v[64:79]
    ds_read_b64_tr_b16 a[116:117], v5 offset:2048
    ds_read_b64_tr_b16 a[118:119], v5 offset:2560
    s_add_u32 m0, s88, 16384
    s_add_u32 s96, s10, 196608
    s_and_b32 s96, s96, 0x1fffff
    s_add_u32 s96, s96, s32
    buffer_load_dwordx4 v4, s[40:43], s96 offen lds
    s_waitcnt lgkmcnt(2)
    v_mfma_f32_32x32x16_bf16 v[80:95], v[24:27], a[112:115], v[80:95]
    ds_read_b128 v[32:35], v9 offset:16384
    ds_read_b128 v[36:39], v9 offset:24576
    s_add_u32 m0, s88, 24576
    s_add_u32 s96, s10, 196608
    s_and_b32 s96, s96, 0x1fffff
    s_add_u32 s96, s96, s33
    buffer_load_dwordx4 v4, s[40:43], s96 offen lds
    s_waitcnt lgkmcnt(1)
    v_mfma_f32_32x32x16_bf16 v[64:79], v[32:35], a[116:119], v[64:79]
    ds_read_b64_tr_b16 a[120:121], v5 offset:4096
    ds_read_b64_tr_b16 a[122:123], v5 offset:4608
    s_waitcnt lgkmcnt(2)
    v_mfma_f32_32x32x16_bf16 v[80:95], v[36:39], a[116:119], v[80:95]
    ds_read_b128 v[20:23], v10 offset:16384
    ds_read_b128 v[24:27], v10 offset:24576
    s_waitcnt lgkmcnt(1)
    v_mfma_f32_32x32x16_bf16 v[64:79], v[20:23], a[120:123], v[64:79]
    ds_read_b64_tr_b16 a[124:125], v5 offset:6144
    ds_read_b64_tr_b16 a[126:127], v5 offset:6656
    s_waitcnt lgkmcnt(2)
    v_mfma_f32_32x32x16_bf16 v[80:95], v[24:27], a[120:123], v[80:95]
    ds_read_b128 v[32:35], v11 offset:16384
    ds_read_b128 v[36:39], v11 offset:24576
    s_waitcnt lgkmcnt(0)
    s_waitcnt vmcnt(4)
    s_barrier
    v_add_u32 v8, s34, v8
    v_add_u32 v9, s34, v9
    v_add_u32 v10, s34, v10
    v_add_u32 v11, s34, v11
    v_mfma_f32_32x32x16_bf16 v[64:79], v[32:35], a[124:127], v[64:79]
    ds_read_b128 v[20:23], v8 offset:0
    ds_read_b128 v[24:27], v9 offset:0
    s_add_u32 m0, s88, 40960
    s_add_u32 s96, s10, 229376
    s_and_b32 s96, s96, 0x1fffff
    s_add_u32 s96, s96, s30
    buffer_load_dwordx4 v4, s[40:43], s96 offen lds
    v_mfma_f32_32x32x16_bf16 v[80:95], v[36:39], a[124:127], v[80:95]
    ds_read_b128 v[28:31], v10 offset:0
    s_add_u32 m0, s88, 49152
    s_add_u32 s96, s10, 229376
    s_and_b32 s96, s96, 0x1fffff
    s_add_u32 s96, s96, s31
    buffer_load_dwordx4 v4, s[40:43], s96 offen lds
    ds_read_b128 v[32:35], v11 offset:0
    ds_read_b128 v[36:39], v8 offset:4096
    s_waitcnt lgkmcnt(4)
    v_mfma_f32_32x32x16_bf16 v[96:111], v[20:23], a[0:3], 0
    ds_read_b128 v[40:43], v9 offset:4096
    s_add_u32 m0, s88, 57344
    s_add_u32 s96, s10, 229376
    s_and_b32 s96, s96, 0x1fffff
    s_add_u32 s96, s96, s32
    buffer_load_dwordx4 v4, s[40:43], s96 offen lds
    v_permlane16_swap_b32 v64, v80
    v_permlane16_swap_b32 v65, v81
    v_permlane16_swap_b32 v66, v82
    s_waitcnt lgkmcnt(4)
    v_mfma_f32_32x32x16_bf16 v[96:111], v[24:27], a[4:7], v[96:111]
    ds_read_b128 v[20:23], v10 offset:4096
    s_add_u32 m0, s88, 65536
    s_add_u32 s96, s10, 229376
    s_and_b32 s96, s96, 0x1fffff
    s_add_u32 s96, s96, s33
    buffer_load_dwordx4 v4, s[40:43], s96 offen lds
    v_permlane16_swap_b32 v67, v83
    v_permlane16_swap_b32 v68, v84
    v_permlane16_swap_b32 v69, v85
    s_waitcnt lgkmcnt(4)
    v_mfma_f32_32x32x16_bf16 v[96:111], v[28:31], a[8:11], v[96:111]
    ds_read_b128 v[24:27], v11 offset:4096
    v_permlane16_swap_b32 v70, v86
    v_permlane16_swap_b32 v71, v87
    v_permlane16_swap_b32 v72, v88
    v_permlane16_swap_b32 v73, v89
    v_permlane16_swap_b32 v74, v90
    v_permlane16_swap_b32 v75, v91
    v_permlane16_swap_b32 v76, v92
    s_waitcnt lgkmcnt(4)
    v_mfma_f32_32x32x16_bf16 v[96:111], v[32:35], a[12:15], v[96:111]
    ds_read_b128 v[28:31], v8 offset:8192
    v_permlane16_swap_b32 v77, v93
    v_permlane16_swap_b32 v78, v94
    v_permlane16_swap_b32 v79, v95
    v_mul_f32 v12, s91, v64
    v_mul_f32 v13, s91, v65
    v_mul_f32 v14, s91, v66
    v_mul_f32 v15, s91, v67
    s_waitcnt lgkmcnt(4)
    v_mfma_f32_32x32x16_bf16 v[96:111], v[36:39], a[16:19], v[96:111]
    ds_read_b128 v[32:35], v9 offset:8192
    v_mul_f32 v16, s91, v68
    v_mul_f32 v17, s91, v69
    v_mul_f32 v18, s91, v70
    v_mul_f32 v19, s91, v71
    v_exp_f32_e64 v12, v12 clamp
    s_waitcnt lgkmcnt(4)
    v_mfma_f32_32x32x16_bf16 v[96:111], v[40:43], a[20:23], v[96:111]
    ds_read_b128 v[36:39], v10 offset:8192
    v_exp_f32_e64 v13, v13 clamp
    v_exp_f32_e64 v14, v14 clamp
    v_exp_f32_e64 v15, v15 clamp
    s_waitcnt lgkmcnt(4)
    v_mfma_f32_32x32x16_bf16 v[96:111], v[20:23], a[24:27], v[96:111]
    ds_read_b128 v[40:43], v11 offset:8192
    v_exp_f32_e64 v16, v16 clamp
    v_exp_f32_e64 v17, v17 clamp
    v_exp_f32_e64 v18, v18 clamp
    s_waitcnt lgkmcnt(4)
    v_mfma_f32_32x32x16_bf16 v[96:111], v[24:27], a[28:31], v[96:111]
    ds_read_b128 v[20:23], v8 offset:12288
    v_exp_f32_e64 v19, v19 clamp
    v_max_f32 v64, 0, v64
    v_max_f32 v65, 0, v65
    v_max_f32 v66, 0, v66
    v_max_f32 v67, 0, v67
    v_max_f32 v68, 0, v68
    s_waitcnt lgkmcnt(4)
    v_mfma_f32_32x32x16_bf16 v[96:111], v[28:31], a[32:35], v[96:111]
    ds_read_b128 v[24:27], v9 offset:12288
    v_max_f32 v69, 0, v69
    v_max_f32 v70, 0, v70
    v_max_f32 v71, 0, v71
    v_add_f32 v64, v64, v12
    v_add_f32 v65, v65, v13
    v_add_f32 v66, v66, v14
    v_add_f32 v67, v67, v15
    s_waitcnt lgkmcnt(4)
    v_mfma_f32_32x32x16_bf16 v[96:111], v[32:35], a[36:39], v[96:111]
    ds_read_b128 v[28:31], v10 offset:12288
    v_add_f32 v68, v68, v16
    v_add_f32 v69, v69, v17
    v_add_f32 v70, v70, v18
    v_add_f32 v71, v71, v19
    v_add_f32 v64, s93, v64
    v_add_f32 v65, s93, v65
    v_add_f32 v66, s93, v66
    s_waitcnt lgkmcnt(4)
    v_mfma_f32_32x32x16_bf16 v[96:111], v[36:39], a[40:43], v[96:111]
    ds_read_b128 v[32:35], v11 offset:12288
    v_add_f32 v67, s93, v67
    v_add_f32 v68, s93, v68
    v_add_f32 v69, s93, v69
    v_add_f32 v70, s93, v70
    v_add_f32 v71, s93, v71
    v_mul_f32 v12, s91, v72
    v_mul_f32 v13, s91, v73
    s_waitcnt lgkmcnt(4)
    v_mfma_f32_32x32x16_bf16 v[96:111], v[40:43], a[44:47], v[96:111]
    ds_read_b128 v[36:39], v8 offset:16384
    v_mul_f32 v14, s91, v74
    v_mul_f32 v15, s91, v75
    v_mul_f32 v16, s91, v76
    v_mul_f32 v17, s91, v77
    v_mul_f32 v18, s91, v78
    v_mul_f32 v19, s91, v79
    s_waitcnt lgkmcnt(4)
    v_mfma_f32_32x32x16_bf16 v[96:111], v[20:23], a[48:51], v[96:111]
    ds_read_b128 v[40:43], v9 offset:16384
    v_exp_f32_e64 v12, v12 clamp
    v_exp_f32_e64 v13, v13 clamp
    v_exp_f32_e64 v14, v14 clamp
    s_waitcnt lgkmcnt(4)
    v_mfma_f32_32x32x16_bf16 v[96:111], v[24:27], a[52:55], v[96:111]
    ds_read_b128 v[20:23], v10 offset:16384
    v_exp_f32_e64 v15, v15 clamp
    v_exp_f32_e64 v16, v16 clamp
    v_exp_f32_e64 v17, v17 clamp
    s_waitcnt lgkmcnt(4)
    v_mfma_f32_32x32x16_bf16 v[96:111], v[28:31], a[56:59], v[96:111]
    ds_read_b128 v[24:27], v11 offset:16384
    v_exp_f32_e64 v18, v18 clamp
    v_exp_f32_e64 v19, v19 clamp
    v_max_f32 v72, 0, v72
    v_max_f32 v73, 0, v73
    v_max_f32 v74, 0, v74
    s_waitcnt lgkmcnt(4)
    v_mfma_f32_32x32x16_bf16 v[96:111], v[32:35], a[60:63], v[96:111]
    ds_read_b128 v[28:31], v8 offset:20480
    v_max_f32 v75, 0, v75
    v_max_f32 v76, 0, v76
    v_max_f32 v77, 0, v77
    v_max_f32 v78, 0, v78
    v_max_f32 v79, 0, v79
    v_add_f32 v72, v72, v12
    v_add_f32 v73, v73, v13
    s_waitcnt lgkmcnt(4)
    v_mfma_f32_32x32x16_bf16 v[96:111], v[36:39], a[64:67], v[96:111]
    ds_read_b128 v[32:35], v9 offset:20480
    v_add_f32 v74, v74, v14
    v_add_f32 v75, v75, v15
    v_add_f32 v76, v76, v16
    v_add_f32 v77, v77, v17
    v_add_f32 v78, v78, v18
    v_add_f32 v79, v79, v19
    v_add_f32 v72, s93, v72
    s_waitcnt lgkmcnt(4)
    v_mfma_f32_32x32x16_bf16 v[96:111], v[40:43], a[68:71], v[96:111]
    ds_read_b128 v[36:39], v10 offset:20480
    v_add_f32 v73, s93, v73
    v_add_f32 v74, s93, v74
    v_add_f32 v75, s93, v75
    v_add_f32 v76, s93, v76
    v_add_f32 v77, s93, v77
    v_add_f32 v78, s93, v78
    v_add_f32 v79, s93, v79
    s_waitcnt lgkmcnt(4)
    v_mfma_f32_32x32x16_bf16 v[96:111], v[20:23], a[72:75], v[96:111]
    ds_read_b128 v[40:43], v11 offset:20480
    v_cvt_pk_bf16_f32 v80, v80, v81
    v_cvt_pk_bf16_f32 v81, v82, v83
    v_cvt_pk_bf16_f32 v82, v84, v85
    v_cvt_pk_bf16_f32 v83, v86, v87
    v_cvt_pk_bf16_f32 v84, v88, v89
    v_cvt_pk_bf16_f32 v85, v90, v91
    v_cvt_pk_bf16_f32 v86, v92, v93
    s_waitcnt lgkmcnt(4)
    v_mfma_f32_32x32x16_bf16 v[96:111], v[24:27], a[76:79], v[96:111]
    ds_read_b128 v[20:23], v8 offset:24576
    v_cvt_pk_bf16_f32 v87, v94, v95
    v_mov_b32 v7, v64
    v_add_f32 v7, v7, v65
    v_add_f32 v7, v7, v66
    v_add_f32 v7, v7, v67
    v_add_f32 v7, v7, v68
    v_add_f32 v7, v7, v69
    s_waitcnt lgkmcnt(4)
    v_mfma_f32_32x32x16_bf16 v[96:111], v[28:31], a[80:83], v[96:111]
    ds_read_b128 v[24:27], v9 offset:24576
    v_add_f32 v7, v7, v70
    v_add_f32 v7, v7, v71
    v_add_f32 v7, v7, v72
    v_add_f32 v7, v7, v73
    v_add_f32 v7, v7, v74
    v_add_f32 v7, v7, v75
    v_add_f32 v7, v7, v76
    s_waitcnt lgkmcnt(4)
    v_mfma_f32_32x32x16_bf16 v[96:111], v[32:35], a[84:87], v[96:111]
    ds_read_b128 v[28:31], v10 offset:24576
    v_add_f32 v7, v7, v77
    v_add_f32 v7, v7, v78
    v_add_f32 v7, v7, v79
    v_cvt_pk_bf16_f32 v64, v64, v65
    v_cvt_pk_bf16_f32 v65, v66, v67
    v_cvt_pk_bf16_f32 v66, v68, v69
    v_cvt_pk_bf16_f32 v67, v70, v71
    s_waitcnt lgkmcnt(4)
    v_mfma_f32_32x32x16_bf16 v[96:111], v[36:39], a[88:91], v[96:111]
    ds_read_b128 v[32:35], v11 offset:24576
    v_cvt_pk_bf16_f32 v68, v72, v73
    v_cvt_pk_bf16_f32 v69, v74, v75
    v_cvt_pk_bf16_f32 v70, v76, v77
    v_cvt_pk_bf16_f32 v71, v78, v79
    s_waitcnt lgkmcnt(4)
    v_mfma_f32_32x32x16_bf16 v[96:111], v[40:43], a[92:95], v[96:111]
    ds_read_b128 v[36:39], v8 offset:28672
    s_nop 1
    v_mfma_f32_32x32x16_bf16 v[48:63], v[64:67], v[80:83], 0
    v_mfma_f32_32x32x16_bf16 v[48:63], v[68:71], v[84:87], v[48:63]
    s_waitcnt lgkmcnt(4)
    v_mfma_f32_32x32x16_bf16 v[96:111], v[20:23], a[96:99], v[96:111]
    ds_read_b128 v[40:43], v9 offset:28672
    s_waitcnt lgkmcnt(4)
    v_mfma_f32_32x32x16_bf16 v[96:111], v[24:27], a[100:103], v[96:111]
    ds_read_b128 v[20:23], v10 offset:28672
    s_waitcnt lgkmcnt(4)
    v_mfma_f32_32x32x16_bf16 v[96:111], v[28:31], a[104:107], v[96:111]
    ds_read_b128 v[24:27], v11 offset:28672
    s_waitcnt vmcnt(0) lgkmcnt(0)
    s_barrier
    v_add_u32 v8, s35, v8
    v_add_u32 v9, s35, v9
    v_add_u32 v10, s35, v10
    v_add_u32 v11, s35, v11
    v_mfma_f32_32x32x16_bf16 v[96:111], v[32:35], a[108:111], v[96:111]
    ds_read_b128 v[28:31], v8 offset:0
    v_mfma_f32_32x32x16_bf16 v[96:111], v[36:39], a[112:115], v[96:111]
    ds_read_b128 v[32:35], v9 offset:0
    v_mfma_f32_32x32x16_bf16 v[96:111], v[40:43], a[116:119], v[96:111]
    ds_read_b128 v[36:39], v10 offset:0
    v_mfma_f32_32x32x16_bf16 v[96:111], v[20:23], a[120:123], v[96:111]
    ds_read_b128 v[40:43], v11 offset:0
    v_mfma_f32_32x32x16_bf16 v[96:111], v[24:27], a[124:127], v[96:111]
    ds_read_b128 v[20:23], v8 offset:4096
    s_waitcnt lgkmcnt(4)
    v_mfma_f32_32x32x16_bf16 v[112:127], v[28:31], a[0:3], 0
    ds_read_b128 v[24:27], v9 offset:4096
    s_waitcnt lgkmcnt(4)
    v_mfma_f32_32x32x16_bf16 v[112:127], v[32:35], a[4:7], v[112:127]
    ds_read_b128 v[28:31], v10 offset:4096
    s_waitcnt lgkmcnt(4)
    v_mfma_f32_32x32x16_bf16 v[112:127], v[36:39], a[8:11], v[112:127]
    ds_read_b128 v[32:35], v11 offset:4096
    s_waitcnt lgkmcnt(4)
    v_mfma_f32_32x32x16_bf16 v[112:127], v[40:43], a[12:15], v[112:127]
    ds_read_b128 v[36:39], v8 offset:8192
    s_waitcnt lgkmcnt(4)
    v_mfma_f32_32x32x16_bf16 v[112:127], v[20:23], a[16:19], v[112:127]
    ds_read_b128 v[40:43], v9 offset:8192
    s_waitcnt lgkmcnt(4)
    v_mfma_f32_32x32x16_bf16 v[112:127], v[24:27], a[20:23], v[112:127]
    ds_read_b128 v[20:23], v10 offset:8192
    s_waitcnt lgkmcnt(4)
    v_mfma_f32_32x32x16_bf16 v[112:127], v[28:31], a[24:27], v[112:127]
    ds_read_b128 v[24:27], v11 offset:8192
    s_waitcnt lgkmcnt(4)
    v_mfma_f32_32x32x16_bf16 v[112:127], v[32:35], a[28:31], v[112:127]
    ds_read_b128 v[28:31], v8 offset:12288
    s_waitcnt lgkmcnt(4)
    v_mfma_f32_32x32x16_bf16 v[112:127], v[36:39], a[32:35], v[112:127]
    ds_read_b128 v[32:35], v9 offset:12288
    s_waitcnt lgkmcnt(4)
    v_mfma_f32_32x32x16_bf16 v[112:127], v[40:43], a[36:39], v[112:127]
    ds_read_b128 v[36:39], v10 offset:12288
    s_waitcnt lgkmcnt(4)
    v_mfma_f32_32x32x16_bf16 v[112:127], v[20:23], a[40:43], v[112:127]
    ds_read_b128 v[40:43], v11 offset:12288
    s_waitcnt lgkmcnt(4)
    v_mfma_f32_32x32x16_bf16 v[112:127], v[24:27], a[44:47], v[112:127]
    ds_read_b128 v[20:23], v8 offset:16384
    s_waitcnt lgkmcnt(4)
    v_mfma_f32_32x32x16_bf16 v[112:127], v[28:31], a[48:51], v[112:127]
    ds_read_b128 v[24:27], v9 offset:16384
    s_waitcnt lgkmcnt(4)
    v_mfma_f32_32x32x16_bf16 v[112:127], v[32:35], a[52:55], v[112:127]
    ds_read_b128 v[28:31], v10 offset:16384
    s_waitcnt lgkmcnt(4)
    v_mfma_f32_32x32x16_bf16 v[112:127], v[36:39], a[56:59], v[112:127]
    ds_read_b128 v[32:35], v11 offset:16384
    s_waitcnt lgkmcnt(4)
    v_mfma_f32_32x32x16_bf16 v[112:127], v[40:43], a[60:63], v[112:127]
    ds_read_b128 v[36:39], v8 offset:20480
    s_waitcnt lgkmcnt(4)
    v_mfma_f32_32x32x16_bf16 v[112:127], v[20:23], a[64:67], v[112:127]
    ds_read_b128 v[40:43], v9 offset:20480
    s_waitcnt lgkmcnt(4)
    v_mfma_f32_32x32x16_bf16 v[112:127], v[24:27], a[68:71], v[112:127]
    ds_read_b128 v[20:23], v10 offset:20480
    s_waitcnt lgkmcnt(4)
    v_mfma_f32_32x32x16_bf16 v[112:127], v[28:31], a[72:75], v[112:127]
    ds_read_b128 v[24:27], v11 offset:20480
    s_waitcnt lgkmcnt(4)
    v_mfma_f32_32x32x16_bf16 v[112:127], v[32:35], a[76:79], v[112:127]
    ds_read_b128 v[28:31], v8 offset:24576
    s_waitcnt lgkmcnt(4)
    v_mfma_f32_32x32x16_bf16 v[112:127], v[36:39], a[80:83], v[112:127]
    ds_read_b128 v[32:35], v9 offset:24576
    s_waitcnt lgkmcnt(4)
    v_mfma_f32_32x32x16_bf16 v[112:127], v[40:43], a[84:87], v[112:127]
    ds_read_b128 v[36:39], v10 offset:24576
    s_waitcnt lgkmcnt(4)
    v_mfma_f32_32x32x16_bf16 v[112:127], v[20:23], a[88:91], v[112:127]
    ds_read_b128 v[40:43], v11 offset:24576
    s_waitcnt lgkmcnt(4)
    v_mfma_f32_32x32x16_bf16 v[112:127], v[24:27], a[92:95], v[112:127]
    ds_read_b128 v[20:23], v8 offset:28672
    s_waitcnt lgkmcnt(4)
    v_mfma_f32_32x32x16_bf16 v[112:127], v[28:31], a[96:99], v[112:127]
    ds_read_b128 v[24:27], v9 offset:28672
    s_waitcnt lgkmcnt(4)
    v_mfma_f32_32x32x16_bf16 v[112:127], v[32:35], a[100:103], v[112:127]
    ds_read_b128 v[28:31], v10 offset:28672
    s_waitcnt lgkmcnt(4)
    v_mfma_f32_32x32x16_bf16 v[112:127], v[36:39], a[104:107], v[112:127]
    ds_read_b128 v[32:35], v11 offset:28672
    s_waitcnt lgkmcnt(4)
    v_mfma_f32_32x32x16_bf16 v[112:127], v[40:43], a[108:111], v[112:127]
    s_waitcnt lgkmcnt(3)
    v_mfma_f32_32x32x16_bf16 v[112:127], v[20:23], a[112:115], v[112:127]
    s_waitcnt lgkmcnt(2)
    v_mfma_f32_32x32x16_bf16 v[112:127], v[24:27], a[116:119], v[112:127]
    s_waitcnt lgkmcnt(1)
    v_mfma_f32_32x32x16_bf16 v[112:127], v[28:31], a[120:123], v[112:127]
    s_waitcnt lgkmcnt(0)
    v_mfma_f32_32x32x16_bf16 v[112:127], v[32:35], a[124:127], v[112:127]
    s_lshl_b32 s12, s97, 8
    s_lshl_b32 s13, s4, 5
    s_add_u32 s12, s12, s13
    s_lshl_b32 s13, s6, 2
    s_add_u32 s14, s12, s13
    s_lshl_b32 s12, s14, 10
    s_nop 3
    buffer_load_dwordx4 v[20:23], v6, s[56:59], 0 offen
    buffer_load_dwordx4 v[24:27], v6, s[40:43], s12 offen offset:0
    buffer_load_dwordx4 v[28:31], v6, s[40:43], s12 offen offset:1024
    buffer_load_dwordx4 v[32:35], v6, s[40:43], s12 offen offset:2048
    buffer_load_dwordx4 v[36:39], v6, s[40:43], s12 offen offset:3072
    v_permlane16_swap_b32 v96, v112
    v_permlane16_swap_b32 v97, v113
    v_permlane16_swap_b32 v98, v114
    v_permlane16_swap_b32 v99, v115
    v_permlane16_swap_b32 v100, v116
    v_permlane16_swap_b32 v101, v117
    v_permlane16_swap_b32 v102, v118
    v_permlane16_swap_b32 v103, v119
    v_permlane16_swap_b32 v104, v120
    v_permlane16_swap_b32 v105, v121
    v_permlane16_swap_b32 v106, v122
    v_permlane16_swap_b32 v107, v123
    v_permlane16_swap_b32 v108, v124
    v_permlane16_swap_b32 v109, v125
    v_permlane16_swap_b32 v110, v126
    v_permlane16_swap_b32 v111, v127
    v_mul_f32 v12, s91, v96
    v_mul_f32 v13, s91, v97
    v_mul_f32 v14, s91, v98
    v_mul_f32 v15, s91, v99
    v_mul_f32 v16, s91, v100
    v_mul_f32 v17, s91, v101
    v_mul_f32 v18, s91, v102
    v_mul_f32 v19, s91, v103
    v_exp_f32_e64 v12, v12 clamp
    v_exp_f32_e64 v13, v13 clamp
    v_exp_f32_e64 v14, v14 clamp
    v_exp_f32_e64 v15, v15 clamp
    v_exp_f32_e64 v16, v16 clamp
    v_exp_f32_e64 v17, v17 clamp
    v_exp_f32_e64 v18, v18 clamp
    v_exp_f32_e64 v19, v19 clamp
    v_max_f32 v96, 0, v96
    v_max_f32 v97, 0, v97
    v_max_f32 v98, 0, v98
    v_max_f32 v99, 0, v99
    v_max_f32 v100, 0, v100
    v_max_f32 v101, 0, v101
    v_max_f32 v102, 0, v102
    v_max_f32 v103, 0, v103
    v_add_f32 v96, v96, v12
    v_add_f32 v97, v97, v13
    v_add_f32 v98, v98, v14
    v_add_f32 v99, v99, v15
    v_add_f32 v100, v100, v16
    v_add_f32 v101, v101, v17
    v_add_f32 v102, v102, v18
    v_add_f32 v103, v103, v19
    v_add_f32 v96, s93, v96
    v_add_f32 v97, s93, v97
    v_add_f32 v98, s93, v98
    v_add_f32 v99, s93, v99
    v_add_f32 v100, s93, v100
    v_add_f32 v101, s93, v101
    v_add_f32 v102, s93, v102
    v_add_f32 v103, s93, v103
    v_mul_f32 v12, s91, v104
    v_mul_f32 v13, s91, v105
    v_mul_f32 v14, s91, v106
    v_mul_f32 v15, s91, v107
    v_mul_f32 v16, s91, v108
    v_mul_f32 v17, s91, v109
    v_mul_f32 v18, s91, v110
    v_mul_f32 v19, s91, v111
    v_exp_f32_e64 v12, v12 clamp
    v_exp_f32_e64 v13, v13 clamp
    v_exp_f32_e64 v14, v14 clamp
    v_exp_f32_e64 v15, v15 clamp
    v_exp_f32_e64 v16, v16 clamp
    v_exp_f32_e64 v17, v17 clamp
    v_exp_f32_e64 v18, v18 clamp
    v_exp_f32_e64 v19, v19 clamp
    v_max_f32 v104, 0, v104
    v_max_f32 v105, 0, v105
    v_max_f32 v106, 0, v106
    v_max_f32 v107, 0, v107
    v_max_f32 v108, 0, v108
    v_max_f32 v109, 0, v109
    v_max_f32 v110, 0, v110
    v_max_f32 v111, 0, v111
    v_add_f32 v104, v104, v12
    v_add_f32 v105, v105, v13
    v_add_f32 v106, v106, v14
    v_add_f32 v107, v107, v15
    v_add_f32 v108, v108, v16
    v_add_f32 v109, v109, v17
    v_add_f32 v110, v110, v18
    v_add_f32 v111, v111, v19
    v_add_f32 v104, s93, v104
    v_add_f32 v105, s93, v105
    v_add_f32 v106, s93, v106
    v_add_f32 v107, s93, v107
    v_add_f32 v108, s93, v108
    v_add_f32 v109, s93, v109
    v_add_f32 v110, s93, v110
    v_add_f32 v111, s93, v111
    v_cvt_pk_bf16_f32 v112, v112, v113
    v_cvt_pk_bf16_f32 v113, v114, v115
    v_cvt_pk_bf16_f32 v114, v116, v117
    v_cvt_pk_bf16_f32 v115, v118, v119
    v_cvt_pk_bf16_f32 v116, v120, v121
    v_cvt_pk_bf16_f32 v117, v122, v123
    v_cvt_pk_bf16_f32 v118, v124, v125
    v_cvt_pk_bf16_f32 v119, v126, v127
    v_add_f32 v7, v7, v96
    v_add_f32 v7, v7, v97
    v_add_f32 v7, v7, v98
    v_add_f32 v7, v7, v99
    v_add_f32 v7, v7, v100
    v_add_f32 v7, v7, v101
    v_add_f32 v7, v7, v102
    v_add_f32 v7, v7, v103
    v_add_f32 v7, v7, v104
    v_add_f32 v7, v7, v105
    v_add_f32 v7, v7, v106
    v_add_f32 v7, v7, v107
    v_add_f32 v7, v7, v108
    v_add_f32 v7, v7, v109
    v_add_f32 v7, v7, v110
    v_add_f32 v7, v7, v111
    v_cvt_pk_bf16_f32 v96, v96, v97
    v_cvt_pk_bf16_f32 v97, v98, v99
    v_cvt_pk_bf16_f32 v98, v100, v101
    v_cvt_pk_bf16_f32 v99, v102, v103
    v_cvt_pk_bf16_f32 v100, v104, v105
    v_cvt_pk_bf16_f32 v101, v106, v107
    v_cvt_pk_bf16_f32 v102, v108, v109
    v_cvt_pk_bf16_f32 v103, v110, v111
    s_nop 1
    v_mfma_f32_32x32x16_bf16 v[48:63], v[96:99], v[112:115], v[48:63]
    v_mfma_f32_32x32x16_bf16 v[48:63], v[100:103], v[116:119], v[48:63]
    s_nop 15
    v_permlane16_swap_b32 v56, v12
    v_permlane16_swap_b32 v57, v13
    v_permlane16_swap_b32 v58, v14
    v_permlane16_swap_b32 v59, v15
    v_permlane16_swap_b32 v60, v16
    v_permlane16_swap_b32 v61, v17
    v_permlane16_swap_b32 v62, v18
    v_permlane16_swap_b32 v63, v19
    v_mov_b32 v64, v7
    s_nop 1
    v_permlane16_swap_b32 v64, v7
    s_nop 0
    v_add_f32 v7, v7, v64
    v_mov_b32 v64, v7
    s_nop 1
    v_permlane32_swap_b32 v64, v7
    s_nop 0
    v_add_f32 v7, v7, v64
    v_add_f32 v48, v48, v12
    v_add_f32 v49, v49, v13
    v_add_f32 v50, v50, v14
    v_add_f32 v51, v51, v15
    v_add_f32 v52, v52, v16
    v_add_f32 v53, v53, v17
    v_add_f32 v54, v54, v18
    v_add_f32 v55, v55, v19
    s_mul_i32 s13, s6, 1152
    s_add_u32 s13, s13, 122880
    v_and_b32 v64, 15, v1
    v_lshrrev_b32 v65, 5, v1
    v_lshl_add_u32 v65, v65, 4, v64
    v_lshlrev_b32 v65, 5, v65
    v_add_u32 v65, s13, v65
    v_and_b32 v66, 3, v64
    v_lshrrev_b32 v67, 3, v64
    v_lshl_add_u32 v66, v67, 2, v66
    v_bfe_u32 v67, v64, 2, 1
    v_lshl_add_u32 v66, v67, 3, v66
    v_lshlrev_b32 v66, 2, v66
    v_add_u32 v66, s13, v66
    v_lshlrev_b32 v68, 2, v1
    v_add_u32 v67, s13, v68
    s_mov_b32 s94, 0xffff
    s_mov_b32 s95, 0xffff
    s_mov_b64 exec, s[94:95]
    ds_write_b128 v65, v[48:51]
    ds_write_b128 v65, v[52:55] offset:16
    s_mov_b64 exec, 0xffff
    ds_write_b32 v66, v7 offset:1024
    s_mov_b64 exec, -1
    s_waitcnt lgkmcnt(0)
    ds_read_b32 v72, v67 offset:0
    ds_read_b32 v73, v67 offset:256
    ds_read_b32 v74, v67 offset:512
    ds_read_b32 v75, v67 offset:768
    ds_read_b32 v76, v67 offset:1024
K1_kv_poll:
    s_mov_b64 exec, 1
    v_mov_b32 v13, 0
    buffer_load_dword v12, v13, s[60:63], s11 offen sc1
    s_waitcnt vmcnt(0)
    v_readfirstlane_b32 s12, v12
    s_mov_b64 exec, -1
    s_cmp_lg_u32 s12, 0
    s_cbranch_scc1 K1_kv_go
    s_sleep 8
    s_branch K1_kv_poll
K1_kv_go:
    s_waitcnt lgkmcnt(0)
    buffer_atomic_add_f32 v72, v68, s[52:55], s90 offen offset:0
    buffer_atomic_add_f32 v73, v68, s[52:55], s90 offen offset:256
    buffer_atomic_add_f32 v74, v68, s[52:55], s90 offen offset:512
    buffer_atomic_add_f32 v75, v68, s[52:55], s90 offen offset:768
    s_mov_b64 exec, 0xffff
    buffer_atomic_add_f32 v76, v68, s[52:55], s90 offen offset:1024
    s_mov_b64 exec, -1
    v_lshlrev_b32 v104, 16, v20
    v_and_b32 v105, 0xffff0000, v20
    v_lshlrev_b32 v106, 16, v21
    v_and_b32 v107, 0xffff0000, v21
    v_lshlrev_b32 v108, 16, v22
    v_and_b32 v109, 0xffff0000, v22
    v_lshlrev_b32 v110, 16, v23
    v_and_b32 v111, 0xffff0000, v23
    v_lshlrev_b32 v80, 16, v24
    v_and_b32 v81, 0xffff0000, v24
    v_mul_f32 v80, v80, v104
    v_mul_f32 v81, v81, v105
    v_cvt_pk_bf16_f32 v82, v80, v81
    v_lshlrev_b32 v80, 16, v82
    v_and_b32 v81, 0xffff0000, v82
    v_add_f32 v88, v80, v81
    v_lshlrev_b32 v80, 16, v25
    v_and_b32 v81, 0xffff0000, v25
    v_mul_f32 v80, v80, v106
    v_mul_f32 v81, v81, v107
    v_cvt_pk_bf16_f32 v82, v80, v81
    v_lshlrev_b32 v80, 16, v82
    v_and_b32 v81, 0xffff0000, v82
    v_add_f32 v88, v88, v80
    v_add_f32 v88, v88, v81
    v_lshlrev_b32 v80, 16, v26
    v_and_b32 v81, 0xffff0000, v26
    v_mul_f32 v80, v80, v108
    v_mul_f32 v81, v81, v109
    v_cvt_pk_bf16_f32 v82, v80, v81
    v_lshlrev_b32 v80, 16, v82
    v_and_b32 v81, 0xffff0000, v82
    v_add_f32 v88, v88, v80
    v_add_f32 v88, v88, v81
    v_lshlrev_b32 v80, 16, v27
    v_and_b32 v81, 0xffff0000, v27
    v_mul_f32 v80, v80, v110
    v_mul_f32 v81, v81, v111
    v_cvt_pk_bf16_f32 v82, v80, v81
    v_lshlrev_b32 v80, 16, v82
    v_and_b32 v81, 0xffff0000, v82
    v_add_f32 v88, v88, v80
    v_add_f32 v88, v88, v81
    v_lshlrev_b32 v80, 16, v28
    v_and_b32 v81, 0xffff0000, v28
    v_mul_f32 v80, v80, v104
    v_mul_f32 v81, v81, v105
    v_cvt_pk_bf16_f32 v82, v80, v81
    v_lshlrev_b32 v80, 16, v82
    v_and_b32 v81, 0xffff0000, v82
    v_add_f32 v89, v80, v81
    v_lshlrev_b32 v80, 16, v29
    v_and_b32 v81, 0xffff0000, v29
    v_mul_f32 v80, v80, v106
    v_mul_f32 v81, v81, v107
    v_cvt_pk_bf16_f32 v82, v80, v81
    v_lshlrev_b32 v80, 16, v82
    v_and_b32 v81, 0xffff0000, v82
    v_add_f32 v89, v89, v80
    v_add_f32 v89, v89, v81
    v_lshlrev_b32 v80, 16, v30
    v_and_b32 v81, 0xffff0000, v30
    v_mul_f32 v80, v80, v108
    v_mul_f32 v81, v81, v109
    v_cvt_pk_bf16_f32 v82, v80, v81
    v_lshlrev_b32 v80, 16, v82
    v_and_b32 v81, 0xffff0000, v82
    v_add_f32 v89, v89, v80
    v_add_f32 v89, v89, v81
    v_lshlrev_b32 v80, 16, v31
    v_and_b32 v81, 0xffff0000, v31
    v_mul_f32 v80, v80, v110
    v_mul_f32 v81, v81, v111
    v_cvt_pk_bf16_f32 v82, v80, v81
    v_lshlrev_b32 v80, 16, v82
    v_and_b32 v81, 0xffff0000, v82
    v_add_f32 v89, v89, v80
    v_add_f32 v89, v89, v81
    v_lshlrev_b32 v80, 16, v32
    v_and_b32 v81, 0xffff0000, v32
    v_mul_f32 v80, v80, v104
    v_mul_f32 v81, v81, v105
    v_cvt_pk_bf16_f32 v82, v80, v81
    v_lshlrev_b32 v80, 16, v82
    v_and_b32 v81, 0xffff0000, v82
    v_add_f32 v90, v80, v81
    v_lshlrev_b32 v80, 16, v33
    v_and_b32 v81, 0xffff0000, v33
    v_mul_f32 v80, v80, v106
    v_mul_f32 v81, v81, v107
    v_cvt_pk_bf16_f32 v82, v80, v81
    v_lshlrev_b32 v80, 16, v82
    v_and_b32 v81, 0xffff0000, v82
    v_add_f32 v90, v90, v80
    v_add_f32 v90, v90, v81
    v_lshlrev_b32 v80, 16, v34
    v_and_b32 v81, 0xffff0000, v34
    v_mul_f32 v80, v80, v108
    v_mul_f32 v81, v81, v109
    v_cvt_pk_bf16_f32 v82, v80, v81
    v_lshlrev_b32 v80, 16, v82
    v_and_b32 v81, 0xffff0000, v82
    v_add_f32 v90, v90, v80
    v_add_f32 v90, v90, v81
    v_lshlrev_b32 v80, 16, v35
    v_and_b32 v81, 0xffff0000, v35
    v_mul_f32 v80, v80, v110
    v_mul_f32 v81, v81, v111
    v_cvt_pk_bf16_f32 v82, v80, v81
    v_lshlrev_b32 v80, 16, v82
    v_and_b32 v81, 0xffff0000, v82
    v_add_f32 v90, v90, v80
    v_add_f32 v90, v90, v81
    v_lshlrev_b32 v80, 16, v36
    v_and_b32 v81, 0xffff0000, v36
    v_mul_f32 v80, v80, v104
    v_mul_f32 v81, v81, v105
    v_cvt_pk_bf16_f32 v82, v80, v81
    v_lshlrev_b32 v80, 16, v82
    v_and_b32 v81, 0xffff0000, v82
    v_add_f32 v91, v80, v81
    v_lshlrev_b32 v80, 16, v37
    v_and_b32 v81, 0xffff0000, v37
    v_mul_f32 v80, v80, v106
    v_mul_f32 v81, v81, v107
    v_cvt_pk_bf16_f32 v82, v80, v81
    v_lshlrev_b32 v80, 16, v82
    v_and_b32 v81, 0xffff0000, v82
    v_add_f32 v91, v91, v80
    v_add_f32 v91, v91, v81
    v_lshlrev_b32 v80, 16, v38
    v_and_b32 v81, 0xffff0000, v38
    v_mul_f32 v80, v80, v108
    v_mul_f32 v81, v81, v109
    v_cvt_pk_bf16_f32 v82, v80, v81
    v_lshlrev_b32 v80, 16, v82
    v_and_b32 v81, 0xffff0000, v82
    v_add_f32 v91, v91, v80
    v_add_f32 v91, v91, v81
    v_lshlrev_b32 v80, 16, v39
    v_and_b32 v81, 0xffff0000, v39
    v_mul_f32 v80, v80, v110
    v_mul_f32 v81, v81, v111
    v_cvt_pk_bf16_f32 v82, v80, v81
    v_lshlrev_b32 v80, 16, v82
    v_and_b32 v81, 0xffff0000, v82
    v_add_f32 v91, v91, v80
    v_add_f32 v91, v91, v81
    s_nop 1
    v_add_f32_dpp v88, v88, v88 row_shr:1 row_mask:0xf bank_mask:0xf bound_ctrl:0
    v_add_f32_dpp v89, v89, v89 row_shr:1 row_mask:0xf bank_mask:0xf bound_ctrl:0
    v_add_f32_dpp v90, v90, v90 row_shr:1 row_mask:0xf bank_mask:0xf bound_ctrl:0
    v_add_f32_dpp v91, v91, v91 row_shr:1 row_mask:0xf bank_mask:0xf bound_ctrl:0
    v_add_f32_dpp v88, v88, v88 row_shr:2 row_mask:0xf bank_mask:0xf bound_ctrl:0
    v_add_f32_dpp v89, v89, v89 row_shr:2 row_mask:0xf bank_mask:0xf bound_ctrl:0
    v_add_f32_dpp v90, v90, v90 row_shr:2 row_mask:0xf bank_mask:0xf bound_ctrl:0
    v_add_f32_dpp v91, v91, v91 row_shr:2 row_mask:0xf bank_mask:0xf bound_ctrl:0
    v_add_f32_dpp v88, v88, v88 row_shr:4 row_mask:0xf bank_mask:0xf bound_ctrl:0
    v_add_f32_dpp v89, v89, v89 row_shr:4 row_mask:0xf bank_mask:0xf bound_ctrl:0
    v_add_f32_dpp v90, v90, v90 row_shr:4 row_mask:0xf bank_mask:0xf bound_ctrl:0
    v_add_f32_dpp v91, v91, v91 row_shr:4 row_mask:0xf bank_mask:0xf bound_ctrl:0
    v_add_f32_dpp v88, v88, v88 row_shr:8 row_mask:0xf bank_mask:0xf bound_ctrl:0
    v_add_f32_dpp v89, v89, v89 row_shr:8 row_mask:0xf bank_mask:0xf bound_ctrl:0
    v_add_f32_dpp v90, v90, v90 row_shr:8 row_mask:0xf bank_mask:0xf bound_ctrl:0
    v_add_f32_dpp v91, v91, v91 row_shr:8 row_mask:0xf bank_mask:0xf bound_ctrl:0
    v_add_f32_dpp v88, v88, v88 row_bcast:15 row_mask:0xa bank_mask:0xf
    v_add_f32_dpp v89, v89, v89 row_bcast:15 row_mask:0xa bank_mask:0xf
    v_add_f32_dpp v90, v90, v90 row_bcast:15 row_mask:0xa bank_mask:0xf
    v_add_f32_dpp v91, v91, v91 row_bcast:15 row_mask:0xa bank_mask:0xf
    v_add_f32_dpp v88, v88, v88 row_bcast:31 row_mask:0xc bank_mask:0xf
    v_add_f32_dpp v89, v89, v89 row_bcast:31 row_mask:0xc bank_mask:0xf
    v_add_f32_dpp v90, v90, v90 row_bcast:31 row_mask:0xc bank_mask:0xf
    v_add_f32_dpp v91, v91, v91 row_bcast:31 row_mask:0xc bank_mask:0xf
    v_cvt_pk_bf16_f32 v88, v88, v88
    v_cvt_pk_bf16_f32 v89, v89, v89
    v_cvt_pk_bf16_f32 v90, v90, v90
    v_cvt_pk_bf16_f32 v91, v91, v91
    v_and_b32 v88, 0xffff0000, v88
    v_and_b32 v89, 0xffff0000, v89
    v_and_b32 v90, 0xffff0000, v90
    v_and_b32 v91, 0xffff0000, v91
    v_mul_f32 v88, s92, v88
    v_mul_f32 v89, s92, v89
    v_mul_f32 v90, s92, v90
    v_mul_f32 v91, s92, v91
    v_exp_f32 v88, v88
    v_exp_f32 v89, v89
    v_exp_f32 v90, v90
    v_exp_f32 v91, v91
    v_add_f32 v88, 1.0, v88
    v_add_f32 v89, 1.0, v89
    v_add_f32 v90, 1.0, v90
    v_add_f32 v91, 1.0, v91
    v_rcp_f32 v88, v88
    v_rcp_f32 v89, v89
    v_rcp_f32 v90, v90
    v_rcp_f32 v91, v91
    s_nop 0
    v_cvt_pk_bf16_f32 v88, v88, v88
    v_cvt_pk_bf16_f32 v89, v89, v89
    v_cvt_pk_bf16_f32 v90, v90, v90
    v_cvt_pk_bf16_f32 v91, v91, v91
    v_and_b32 v88, 0xffff0000, v88
    v_and_b32 v89, 0xffff0000, v89
    v_and_b32 v90, 0xffff0000, v90
    v_and_b32 v91, 0xffff0000, v91
    v_sub_f32 v97, 1.0, v88
    v_sub_f32 v99, 1.0, v89
    v_sub_f32 v101, 1.0, v90
    v_sub_f32 v103, 1.0, v91
    v_cvt_pk_bf16_f32 v97, v97, v97
    v_cvt_pk_bf16_f32 v99, v99, v99
    v_cvt_pk_bf16_f32 v101, v101, v101
    v_cvt_pk_bf16_f32 v103, v103, v103
    v_and_b32 v97, 0xffff0000, v97
    v_and_b32 v99, 0xffff0000, v99
    v_and_b32 v101, 0xffff0000, v101
    v_and_b32 v103, 0xffff0000, v103
    v_max_f32 v97, 0x30800000, v97
    v_max_f32 v99, 0x30800000, v99
    v_max_f32 v101, 0x30800000, v101
    v_max_f32 v103, 0x30800000, v103
    v_rcp_f32 v80, v97
    v_rcp_f32 v81, v99
    v_rcp_f32 v82, v101
    v_rcp_f32 v83, v103
    s_nop 0
    v_fma_f32 v84, -v97, v80, 1.0
    v_fma_f32 v85, -v99, v81, 1.0
    v_fma_f32 v86, -v101, v82, 1.0
    v_fma_f32 v87, -v103, v83, 1.0
    v_fma_f32 v80, v84, v80, v80
    v_fma_f32 v81, v85, v81, v81
    v_fma_f32 v82, v86, v82, v82
    v_fma_f32 v83, v87, v83, v83
    v_mul_f32 v96, v88, v80
    v_mul_f32 v98, v89, v81
    v_mul_f32 v100, v90, v82
    v_mul_f32 v102, v91, v83
    s_lshl_b32 s12, s14, 3
    s_add_u32 s12, s12, 9474048
    v_mov_b32 v80, 0
    s_mov_b32 s98, 0
    s_mov_b32 s99, 0x80000000
    s_mov_b64 exec, s[98:99]
    buffer_store_dwordx4 v[96:99], v80, s[52:55], s12 offen sc1
    buffer_store_dwordx4 v[100:103], v80, s[52:55], s12 offen offset:16 sc1
    s_mov_b64 exec, -1
    s_endpgm
K1_done:
    s_endpgm
.globl k2_kernel
.p2align 8
.type k2_kernel,@function
k2_kernel:
    s_cmp_ge_u32 s2, 256
    s_cbranch_scc1 K2_done
    s_load_dwordx2 s[16:17], s[0:1], 16
    s_load_dwordx2 s[18:19], s[0:1], 48
    s_load_dwordx2 s[20:21], s[0:1], 64
    s_load_dwordx2 s[22:23], s[0:1], 80
    s_getpc_b64 s[24:25]
K2_pc:
    s_and_b32 s8, s2, 7
    s_lshr_b32 s9, s2, 3
    v_and_b32 v1, 63, v0
    v_lshrrev_b32 v8, 6, v0
    s_lshl_b32 s10, s9, 9
    v_readfirstlane_b32 s4, v8
    v_lshlrev_b32 v9, 7, v0
    v_add_u32 v9, s10, v9
    v_min_u32 v9, CODE_END-K2_pc-4, v9
    v_cmp_gt_u32 vcc, 4, v0
    s_and_saveexec_b64 s[26:27], vcc
    s_cbranch_execz K2_nopf
    global_load_dword v63, v9, s[24:25]
K2_nopf:
    s_mov_b64 exec, s[26:27]
    s_lshr_b32 s5, s8, 1
    s_lshl_b32 s5, s5, 3
    s_lshr_b32 s10, s9, 2
    s_add_u32 s5, s5, s10
    s_and_b32 s6, s8, 1
    s_lshl_b32 s6, s6, 2
    s_and_b32 s10, s9, 3
    s_add_u32 s6, s6, s10
    s_mul_i32 s8, s5, 294912
    v_lshlrev_b32 v2, 4, v1
    v_add_u32 v2, s8, v2
    v_add_u32 v3, 147456, v2
    s_mul_i32 s12, s4, 28672
    s_mul_i32 s13, s4, 458752
    s_mul_i32 s14, s4, 8192
    s_add_u32 s14, s14, 114688
    s_mul_i32 s15, s4, 131072
    s_mul_i32 s56, s4, 9216
    s_add_u32 s56, s56, 9437184
    s_mul_i32 s7, s4, 16384
    s_add_u32 s7, s7, 69632
    s_mov_b32 s57, 0x358637bd
    v_lshrrev_b32 v8, 3, v1
    v_and_b32 v9, 7, v1
    v_bfe_u32 v10, v1, 4, 1
    v_lshlrev_b32 v10, 2, v10
    v_xor_b32 v9, v9, v10
    v_lshlrev_b32 v8, 10, v8
    v_lshl_add_u32 v4, v9, 4, v8
    s_lshl_b32 s8, s6, 7
    v_add_u32 v4, s8, v4
    s_waitcnt lgkmcnt(0)
    s_mov_b32 s40, s22
    s_and_b32 s41, s23, 0xffff
    s_mov_b32 s42, 9490432
    s_mov_b32 s43, 0x20000
    s_mov_b32 s44, s18
    s_and_b32 s45, s19, 0xffff
    s_mov_b32 s46, 1835008
    s_mov_b32 s47, 0x20000
    s_mov_b32 s48, s16
    s_and_b32 s49, s17, 0xffff
    s_mov_b32 s50, 524288
    s_mov_b32 s51, 0x20000
    s_add_u32 m0, s7, 0
    s_add_u32 s10, s13, 0
    buffer_load_dwordx4 v4, s[44:47], s10 offen lds
    s_add_u32 m0, s7, 1024
    s_add_u32 s10, s13, 8192
    buffer_load_dwordx4 v4, s[44:47], s10 offen lds
    s_add_u32 s9, s12, 0
    buffer_load_dwordx4 a[0:3], v2, s[40:43], s9 offen
    buffer_load_dwordx4 a[4:7], v3, s[40:43], s9 offen
    s_add_u32 m0, s7, 2048
    s_add_u32 s10, s13, 16384
    buffer_load_dwordx4 v4, s[44:47], s10 offen lds
    s_add_u32 m0, s7, 3072
    s_add_u32 s10, s13, 24576
    buffer_load_dwordx4 v4, s[44:47], s10 offen lds
    s_add_u32 s9, s12, 1024
    buffer_load_dwordx4 a[8:11], v2, s[40:43], s9 offen
    buffer_load_dwordx4 a[12:15], v3, s[40:43], s9 offen
    s_add_u32 m0, s7, 4096
    s_add_u32 s10, s13, 32768
    buffer_load_dwordx4 v4, s[44:47], s10 offen lds
    s_add_u32 m0, s7, 5120
    s_add_u32 s10, s13, 40960
    buffer_load_dwordx4 v4, s[44:47], s10 offen lds
    s_add_u32 s9, s12, 2048
    buffer_load_dwordx4 a[16:19], v2, s[40:43], s9 offen
    buffer_load_dwordx4 a[20:23], v3, s[40:43], s9 offen
    s_add_u32 m0, s7, 6144
    s_add_u32 s10, s15, 0
    buffer_load_dwordx4 v4, s[48:51], s10 offen lds
    s_add_u32 m0, s7, 7168
    s_add_u32 s10, s15, 8192
    buffer_load_dwordx4 v4, s[48:51], s10 offen lds
    s_add_u32 s9, s14, 0
    buffer_load_dwordx4 a[24:27], v2, s[40:43], s9 offen
    buffer_load_dwordx4 a[28:31], v3, s[40:43], s9 offen
    s_add_u32 m0, s7, 8192
    s_add_u32 s10, s13, 49152
    buffer_load_dwordx4 v4, s[44:47], s10 offen lds
    s_add_u32 m0, s7, 9216
    s_add_u32 s10, s13, 57344
    buffer_load_dwordx4 v4, s[44:47], s10 offen lds
    s_add_u32 s9, s12, 3072
    buffer_load_dwordx4 a[32:35], v2, s[40:43], s9 offen
    buffer_load_dwordx4 a[36:39], v3, s[40:43], s9 offen
    s_add_u32 m0, s7, 10240
    s_add_u32 s10, s13, 65536
    buffer_load_dwordx4 v4, s[44:47], s10 offen lds
    s_add_u32 m0, s7, 11264
    s_add_u32 s10, s13, 73728
    buffer_load_dwordx4 v4, s[44:47], s10 offen lds
    s_add_u32 s9, s12, 4096
    buffer_load_dwordx4 a[40:43], v2, s[40:43], s9 offen
    buffer_load_dwordx4 a[44:47], v3, s[40:43], s9 offen
    s_add_u32 m0, s7, 12288
    s_add_u32 s10, s13, 81920
    buffer_load_dwordx4 v4, s[44:47], s10 offen lds
    s_add_u32 m0, s7, 13312
    s_add_u32 s10, s13, 90112
    buffer_load_dwordx4 v4, s[44:47], s10 offen lds
    s_add_u32 m0, s7, 14336
    s_add_u32 s10, s15, 16384
    buffer_load_dwordx4 v4, s[48:51], s10 offen lds
    s_add_u32 m0, s7, 15360
    s_add_u32 s10, s15, 24576
    buffer_load_dwordx4 v4, s[48:51], s10 offen lds
    s_mov_b32 s52, s20
    s_and_b32 s53, s21, 0xffff
    s_mov_b32 s54, 2097152
    s_mov_b32 s55, 0x20000
    v_lshrrev_b32 v56, 5, v1
    v_bfe_u32 v57, v1, 2, 2
    v_lshl_add_u32 v56, v56, 2, v57
    v_bfe_u32 v57, v1, 4, 1
    v_bfe_u32 v58, v1, 1, 1
    v_lshl_add_u32 v57, v57, 1, v58
    v_bfe_u32 v58, v1, 3, 1
    v_lshlrev_b32 v58, 2, v58
    v_xor_b32 v57, v57, v58
    v_lshlrev_b32 v56, 7, v56
    v_lshl_add_u32 v56, v57, 4, v56
    v_and_b32 v57, 1, v1
    v_lshl_add_u32 v56, v57, 3, v56
    v_add_u32 v5, s7, v56
    v_xor_b32 v56, 64, v56
    v_add_u32 v6, s7, v56
    v_and_b32 v56, 31, v1
    v_lshrrev_b32 v57, 5, v1
    v_lshl_add_u32 v58, v57, 4, v56
    v_add_u32 v57, 32, v57
    v_cmp_gt_u32 vcc, 16, v56
    v_lshlrev_b32 v18, 3, v56
    s_lshl_b32 s8, s5, 9
    s_add_u32 s8, s8, 9474048
    v_cndmask_b32 v58, v57, v58, vcc
    v_lshlrev_b32 v7, 5, v58
    buffer_load_dword v16, v18, s[40:43], s8 offen
    buffer_load_dword v17, v18, s[40:43], s8 offen offset:256
    s_add_u32 s11, s56, 0
    buffer_load_dwordx4 v[8:11], v7, s[40:43], s11 offen
    buffer_load_dwordx4 v[12:15], v7, s[40:43], s11 offen offset:16
    s_waitcnt vmcnt(28)
    ds_read_b64_tr_b16 v[32:33], v5 offset:0
    ds_read_b64_tr_b16 v[34:35], v5 offset:1024
    ds_read_b64_tr_b16 v[36:37], v6 offset:0
    ds_read_b64_tr_b16 v[38:39], v6 offset:1024
    s_waitcnt vmcnt(24)
    ds_read_b64_tr_b16 v[40:41], v5 offset:2048
    ds_read_b64_tr_b16 v[42:43], v5 offset:3072
    ds_read_b64_tr_b16 v[44:45], v6 offset:2048
    ds_read_b64_tr_b16 v[46:47], v6 offset:3072
    s_waitcnt lgkmcnt(4)
    v_mfma_f32_32x32x16_bf16 v[64:79], v[32:35], a[0:3], 0
    v_mfma_f32_32x32x16_bf16 v[80:95], v[32:35], a[4:7], 0
    v_mfma_f32_32x32x16_bf16 v[96:111], v[36:39], a[0:3], 0
    v_mfma_f32_32x32x16_bf16 v[112:127], v[36:39], a[4:7], 0
    s_add_u32 m0, s7, 0
    s_add_u32 s10, s13, 98304
    buffer_load_dwordx4 v4, s[44:47], s10 offen lds
    s_add_u32 m0, s7, 1024
    s_add_u32 s10, s13, 106496
    buffer_load_dwordx4 v4, s[44:47], s10 offen lds
    s_add_u32 s9, s12, 5120
    buffer_load_dwordx4 a[0:3], v2, s[40:43], s9 offen
    buffer_load_dwordx4 a[4:7], v3, s[40:43], s9 offen
    s_waitcnt vmcnt(24)
    ds_read_b64_tr_b16 v[32:33], v5 offset:4096
    ds_read_b64_tr_b16 v[34:35], v5 offset:5120
    ds_read_b64_tr_b16 v[36:37], v6 offset:4096
    ds_read_b64_tr_b16 v[38:39], v6 offset:5120
    s_waitcnt lgkmcnt(4)
    v_mfma_f32_32x32x16_bf16 v[64:79], v[40:43], a[8:11], v[64:79]
    v_mfma_f32_32x32x16_bf16 v[80:95], v[40:43], a[12:15], v[80:95]
    v_mfma_f32_32x32x16_bf16 v[96:111], v[44:47], a[8:11], v[96:111]
    v_mfma_f32_32x32x16_bf16 v[112:127], v[44:47], a[12:15], v[112:127]
    s_add_u32 m0, s7, 2048
    s_add_u32 s10, s13, 114688
    buffer_load_dwordx4 v4, s[44:47], s10 offen lds
    s_add_u32 m0, s7, 3072
    s_add_u32 s10, s13, 122880
    buffer_load_dwordx4 v4, s[44:47], s10 offen lds
    s_add_u32 s9, s14, 1024
    buffer_load_dwordx4 a[8:11], v2, s[40:43], s9 offen
    buffer_load_dwordx4 a[12:15], v3, s[40:43], s9 offen
    s_waitcnt vmcnt(24)
    ds_read_b64_tr_b16 v[40:41], v5 offset:6144
    ds_read_b64_tr_b16 v[42:43], v5 offset:7168
    ds_read_b64_tr_b16 v[44:45], v6 offset:6144
    ds_read_b64_tr_b16 v[46:47], v6 offset:7168
    s_waitcnt lgkmcnt(4)
    v_mfma_f32_32x32x16_bf16 v[64:79], v[32:35], a[16:19], v[64:79]
    v_mfma_f32_32x32x16_bf16 v[80:95], v[32:35], a[20:23], v[80:95]
    v_mfma_f32_32x32x16_bf16 v[96:111], v[36:39], a[16:19], v[96:111]
    v_mfma_f32_32x32x16_bf16 v[112:127], v[36:39], a[20:23], v[112:127]
    s_add_u32 m0, s7, 4096
    s_add_u32 s10, s13, 131072
    buffer_load_dwordx4 v4, s[44:47], s10 offen lds
    s_add_u32 m0, s7, 5120
    s_add_u32 s10, s13, 139264
    buffer_load_dwordx4 v4, s[44:47], s10 offen lds
    s_add_u32 s9, s12, 6144
    buffer_load_dwordx4 a[16:19], v2, s[40:43], s9 offen
    buffer_load_dwordx4 a[20:23], v3, s[40:43], s9 offen
    s_waitcnt vmcnt(12)
    v_cvt_pk_bf16_f32 v24, v8, v9
    v_cvt_pk_bf16_f32 v25, v10, v11
    v_cvt_pk_bf16_f32 v26, v12, v13
    v_cvt_pk_bf16_f32 v27, v14, v15
    s_nop 1
    v_mfma_f32_32x32x16_bf16 a[64:79], v[24:27], a[24:27], 0
    v_mfma_f32_32x32x16_bf16 a[80:95], v[24:27], a[28:31], 0
    s_add_u32 s11, s56, 1152
    buffer_load_dwordx4 v[8:11], v7, s[40:43], s11 offen
    buffer_load_dwordx4 v[12:15], v7, s[40:43], s11 offen offset:16
    ds_read_b64_tr_b16 v[32:33], v5 offset:8192
    ds_read_b64_tr_b16 v[34:35], v5 offset:9216
    ds_read_b64_tr_b16 v[36:37], v6 offset:8192
    ds_read_b64_tr_b16 v[38:39], v6 offset:9216
    s_nop 4
    v_accvgpr_read_b32 v20, a72
    v_accvgpr_read_b32 v21, a88
    v_add_f32 v20, s57, v20
    v_add_f32 v21, s57, v21
    v_rcp_f32 v20, v20
    v_rcp_f32 v21, v21
    s_nop 0
    v_mul_f32 v20, v20, v16
    v_mul_f32 v21, v21, v17
    v_accvgpr_read_b32 v56, a64
    v_accvgpr_read_b32 v57, a65
    v_accvgpr_read_b32 v58, a66
    v_accvgpr_read_b32 v59, a67
    v_accvgpr_read_b32 v60, a68
    v_accvgpr_read_b32 v61, a69
    v_accvgpr_read_b32 v62, a70
    v_accvgpr_read_b32 v63, a71
    v_mul_f32 v56, v56, v20
    v_mul_f32 v57, v57, v20
    v_mul_f32 v58, v58, v20
    v_mul_f32 v59, v59, v20
    v_mul_f32 v60, v60, v20
    v_mul_f32 v61, v61, v20
    v_mul_f32 v62, v62, v20
    v_mul_f32 v63, v63, v20
    v_cvt_pk_bf16_f32 v48, v56, v57
    v_cvt_pk_bf16_f32 v49, v58, v59
    v_cvt_pk_bf16_f32 v50, v60, v61
    v_cvt_pk_bf16_f32 v51, v62, v63
    v_accvgpr_read_b32 v56, a80
    v_accvgpr_read_b32 v57, a81
    v_accvgpr_read_b32 v58, a82
    v_accvgpr_read_b32 v59, a83
    v_accvgpr_read_b32 v60, a84
    v_accvgpr_read_b32 v61, a85
    v_accvgpr_read_b32 v62, a86
    v_accvgpr_read_b32 v63, a87
    v_mul_f32 v56, v56, v21
    v_mul_f32 v57, v57, v21
    v_mul_f32 v58, v58, v21
    v_mul_f32 v59, v59, v21
    v_mul_f32 v60, v60, v21
    v_mul_f32 v61, v61, v21
    v_mul_f32 v62, v62, v21
    v_mul_f32 v63, v63, v21
    v_cvt_pk_bf16_f32 v52, v56, v57
    v_cvt_pk_bf16_f32 v53, v58, v59
    v_cvt_pk_bf16_f32 v54, v60, v61
    v_cvt_pk_bf16_f32 v55, v62, v63
    s_nop 1
    s_waitcnt lgkmcnt(4)
    v_mfma_f32_32x32x16_bf16 v[64:79], v[40:43], v[48:51], v[64:79]
    v_mfma_f32_32x32x16_bf16 v[80:95], v[40:43], v[52:55], v[80:95]
    v_mfma_f32_32x32x16_bf16 v[96:111], v[44:47], v[48:51], v[96:111]
    v_mfma_f32_32x32x16_bf16 v[112:127], v[44:47], v[52:55], v[112:127]
    s_add_u32 m0, s7, 6144
    s_add_u32 s10, s15, 32768
    buffer_load_dwordx4 v4, s[48:51], s10 offen lds
    s_add_u32 m0, s7, 7168
    s_add_u32 s10, s15, 40960
    buffer_load_dwordx4 v4, s[48:51], s10 offen lds
    s_add_u32 s9, s12, 7168
    buffer_load_dwordx4 a[24:27], v2, s[40:43], s9 offen
    buffer_load_dwordx4 a[28:31], v3, s[40:43], s9 offen
    ds_read_b64_tr_b16 v[40:41], v5 offset:10240
    ds_read_b64_tr_b16 v[42:43], v5 offset:11264
    ds_read_b64_tr_b16 v[44:45], v6 offset:10240
    ds_read_b64_tr_b16 v[46:47], v6 offset:11264
    s_waitcnt lgkmcnt(4)
    v_mfma_f32_32x32x16_bf16 v[64:79], v[32:35], a[32:35], v[64:79]
    v_mfma_f32_32x32x16_bf16 v[80:95], v[32:35], a[36:39], v[80:95]
    v_mfma_f32_32x32x16_bf16 v[96:111], v[36:39], a[32:35], v[96:111]
    v_mfma_f32_32x32x16_bf16 v[112:127], v[36:39], a[36:39], v[112:127]
    s_add_u32 m0, s7, 8192
    s_add_u32 s10, s13, 147456
    buffer_load_dwordx4 v4, s[44:47], s10 offen lds
    s_add_u32 m0, s7, 9216
    s_add_u32 s10, s13, 155648
    buffer_load_dwordx4 v4, s[44:47], s10 offen lds
    s_add_u32 s9, s12, 8192
    buffer_load_dwordx4 a[32:35], v2, s[40:43], s9 offen
    buffer_load_dwordx4 a[36:39], v3, s[40:43], s9 offen
    s_waitcnt vmcnt(18)
    ds_read_b64_tr_b16 v[32:33], v5 offset:12288
    ds_read_b64_tr_b16 v[34:35], v5 offset:13312
    ds_read_b64_tr_b16 v[36:37], v6 offset:12288
    ds_read_b64_tr_b16 v[38:39], v6 offset:13312
    s_waitcnt lgkmcnt(4)
    v_mfma_f32_32x32x16_bf16 v[64:79], v[40:43], a[40:43], v[64:79]
    v_mfma_f32_32x32x16_bf16 v[80:95], v[40:43], a[44:47], v[80:95]
    v_mfma_f32_32x32x16_bf16 v[96:111], v[44:47], a[40:43], v[96:111]
    v_mfma_f32_32x32x16_bf16 v[112:127], v[44:47], a[44:47], v[112:127]
    s_add_u32 m0, s7, 10240
    s_add_u32 s10, s13, 163840
    buffer_load_dwordx4 v4, s[44:47], s10 offen lds
    s_add_u32 m0, s7, 11264
    s_add_u32 s10, s13, 172032
    buffer_load_dwordx4 v4, s[44:47], s10 offen lds
    s_add_u32 s9, s14, 2048
    buffer_load_dwordx4 a[40:43], v2, s[40:43], s9 offen
    buffer_load_dwordx4 a[44:47], v3, s[40:43], s9 offen
    s_waitcnt vmcnt(18)
    ds_read_b64_tr_b16 v[40:41], v5 offset:14336
    ds_read_b64_tr_b16 v[42:43], v5 offset:15360
    ds_read_b64_tr_b16 v[44:45], v6 offset:14336
    ds_read_b64_tr_b16 v[46:47], v6 offset:15360
    s_waitcnt lgkmcnt(4)
    v_mfma_f32_32x32x16_bf16 v[64:79], v[32:35], a[0:3], v[64:79]
    v_mfma_f32_32x32x16_bf16 v[80:95], v[32:35], a[4:7], v[80:95]
    v_mfma_f32_32x32x16_bf16 v[96:111], v[36:39], a[0:3], v[96:111]
    v_mfma_f32_32x32x16_bf16 v[112:127], v[36:39], a[4:7], v[112:127]
    s_add_u32 m0, s7, 12288
    s_add_u32 s10, s13, 180224
    buffer_load_dwordx4 v4, s[44:47], s10 offen lds
    s_add_u32 m0, s7, 13312
    s_add_u32 s10, s13, 188416
    buffer_load_dwordx4 v4, s[44:47], s10 offen lds
    s_add_u32 s9, s12, 9216
    buffer_load_dwordx4 a[0:3], v2, s[40:43], s9 offen
    buffer_load_dwordx4 a[4:7], v3, s[40:43], s9 offen
    s_waitcnt vmcnt(16)
    v_cvt_pk_bf16_f32 v24, v8, v9
    v_cvt_pk_bf16_f32 v25, v10, v11
    v_cvt_pk_bf16_f32 v26, v12, v13
    v_cvt_pk_bf16_f32 v27, v14, v15
    s_nop 1
    v_mfma_f32_32x32x16_bf16 a[64:79], v[24:27], a[8:11], 0
    v_mfma_f32_32x32x16_bf16 a[80:95], v[24:27], a[12:15], 0
    s_add_u32 s11, s56, 2304
    buffer_load_dwordx4 v[8:11], v7, s[40:43], s11 offen
    buffer_load_dwordx4 v[12:15], v7, s[40:43], s11 offen offset:16
    ds_read_b64_tr_b16 v[32:33], v5 offset:0
    ds_read_b64_tr_b16 v[34:35], v5 offset:1024
    ds_read_b64_tr_b16 v[36:37], v6 offset:0
    ds_read_b64_tr_b16 v[38:39], v6 offset:1024
    s_nop 4
    v_accvgpr_read_b32 v20, a72
    v_accvgpr_read_b32 v21, a88
    v_add_f32 v20, s57, v20
    v_add_f32 v21, s57, v21
    v_rcp_f32 v20, v20
    v_rcp_f32 v21, v21
    s_nop 0
    v_mul_f32 v20, v20, v16
    v_mul_f32 v21, v21, v17
    v_accvgpr_read_b32 v56, a64
    v_accvgpr_read_b32 v57, a65
    v_accvgpr_read_b32 v58, a66
    v_accvgpr_read_b32 v59, a67
    v_accvgpr_read_b32 v60, a68
    v_accvgpr_read_b32 v61, a69
    v_accvgpr_read_b32 v62, a70
    v_accvgpr_read_b32 v63, a71
    v_mul_f32 v56, v56, v20
    v_mul_f32 v57, v57, v20
    v_mul_f32 v58, v58, v20
    v_mul_f32 v59, v59, v20
    v_mul_f32 v60, v60, v20
    v_mul_f32 v61, v61, v20
    v_mul_f32 v62, v62, v20
    v_mul_f32 v63, v63, v20
    v_cvt_pk_bf16_f32 v48, v56, v57
    v_cvt_pk_bf16_f32 v49, v58, v59
    v_cvt_pk_bf16_f32 v50, v60, v61
    v_cvt_pk_bf16_f32 v51, v62, v63
    v_accvgpr_read_b32 v56, a80
    v_accvgpr_read_b32 v57, a81
    v_accvgpr_read_b32 v58, a82
    v_accvgpr_read_b32 v59, a83
    v_accvgpr_read_b32 v60, a84
    v_accvgpr_read_b32 v61, a85
    v_accvgpr_read_b32 v62, a86
    v_accvgpr_read_b32 v63, a87
    v_mul_f32 v56, v56, v21
    v_mul_f32 v57, v57, v21
    v_mul_f32 v58, v58, v21
    v_mul_f32 v59, v59, v21
    v_mul_f32 v60, v60, v21
    v_mul_f32 v61, v61, v21
    v_mul_f32 v62, v62, v21
    v_mul_f32 v63, v63, v21
    v_cvt_pk_bf16_f32 v52, v56, v57
    v_cvt_pk_bf16_f32 v53, v58, v59
    v_cvt_pk_bf16_f32 v54, v60, v61
    v_cvt_pk_bf16_f32 v55, v62, v63
    s_nop 1
    s_waitcnt lgkmcnt(4)
    v_mfma_f32_32x32x16_bf16 v[64:79], v[40:43], v[48:51], v[64:79]
    v_mfma_f32_32x32x16_bf16 v[80:95], v[40:43], v[52:55], v[80:95]
    v_mfma_f32_32x32x16_bf16 v[96:111], v[44:47], v[48:51], v[96:111]
    v_mfma_f32_32x32x16_bf16 v[112:127], v[44:47], v[52:55], v[112:127]
    s_add_u32 m0, s7, 14336
    s_add_u32 s10, s15, 49152
    buffer_load_dwordx4 v4, s[48:51], s10 offen lds
    s_add_u32 m0, s7, 15360
    s_add_u32 s10, s15, 57344
    buffer_load_dwordx4 v4, s[48:51], s10 offen lds
    s_add_u32 s9, s12, 10240
    buffer_load_dwordx4 a[8:11], v2, s[40:43], s9 offen
    buffer_load_dwordx4 a[12:15], v3, s[40:43], s9 offen
    s_waitcnt vmcnt(18)
    ds_read_b64_tr_b16 v[40:41], v5 offset:2048
    ds_read_b64_tr_b16 v[42:43], v5 offset:3072
    ds_read_b64_tr_b16 v[44:45], v6 offset:2048
    ds_read_b64_tr_b16 v[46:47], v6 offset:3072
    s_waitcnt lgkmcnt(4)
    v_mfma_f32_32x32x16_bf16 v[64:79], v[32:35], a[16:19], v[64:79]
    v_mfma_f32_32x32x16_bf16 v[80:95], v[32:35], a[20:23], v[80:95]
    v_mfma_f32_32x32x16_bf16 v[96:111], v[36:39], a[16:19], v[96:111]
    v_mfma_f32_32x32x16_bf16 v[112:127], v[36:39], a[20:23], v[112:127]
    s_add_u32 m0, s7, 0
    s_add_u32 s10, s13, 196608
    buffer_load_dwordx4 v4, s[44:47], s10 offen lds
    s_add_u32 m0, s7, 1024
    s_add_u32 s10, s13, 204800
    buffer_load_dwordx4 v4, s[44:47], s10 offen lds
    s_add_u32 s9, s12, 11264
    buffer_load_dwordx4 a[16:19], v2, s[40:43], s9 offen
    buffer_load_dwordx4 a[20:23], v3, s[40:43], s9 offen
    s_waitcnt vmcnt(18)
    ds_read_b64_tr_b16 v[32:33], v5 offset:4096
    ds_read_b64_tr_b16 v[34:35], v5 offset:5120
    ds_read_b64_tr_b16 v[36:37], v6 offset:4096
    ds_read_b64_tr_b16 v[38:39], v6 offset:5120
    s_waitcnt lgkmcnt(4)
    v_mfma_f32_32x32x16_bf16 v[64:79], v[40:43], a[24:27], v[64:79]
    v_mfma_f32_32x32x16_bf16 v[80:95], v[40:43], a[28:31], v[80:95]
    v_mfma_f32_32x32x16_bf16 v[96:111], v[44:47], a[24:27], v[96:111]
    v_mfma_f32_32x32x16_bf16 v[112:127], v[44:47], a[28:31], v[112:127]
    s_add_u32 m0, s7, 2048
    s_add_u32 s10, s13, 212992
    buffer_load_dwordx4 v4, s[44:47], s10 offen lds
    s_add_u32 m0, s7, 3072
    s_add_u32 s10, s13, 221184
    buffer_load_dwordx4 v4, s[44:47], s10 offen lds
    s_add_u32 s9, s14, 3072
    buffer_load_dwordx4 a[24:27], v2, s[40:43], s9 offen
    buffer_load_dwordx4 a[28:31], v3, s[40:43], s9 offen
    s_waitcnt vmcnt(18)
    ds_read_b64_tr_b16 v[40:41], v5 offset:6144
    ds_read_b64_tr_b16 v[42:43], v5 offset:7168
    ds_read_b64_tr_b16 v[44:45], v6 offset:6144
    ds_read_b64_tr_b16 v[46:47], v6 offset:7168
    s_waitcnt lgkmcnt(4)
    v_mfma_f32_32x32x16_bf16 v[64:79], v[32:35], a[32:35], v[64:79]
    v_mfma_f32_32x32x16_bf16 v[80:95], v[32:35], a[36:39], v[80:95]
    v_mfma_f32_32x32x16_bf16 v[96:111], v[36:39], a[32:35], v[96:111]
    v_mfma_f32_32x32x16_bf16 v[112:127], v[36:39], a[36:39], v[112:127]
    s_add_u32 m0, s7, 4096
    s_add_u32 s10, s13, 229376
    buffer_load_dwordx4 v4, s[44:47], s10 offen lds
    s_add_u32 m0, s7, 5120
    s_add_u32 s10, s13, 237568
    buffer_load_dwordx4 v4, s[44:47], s10 offen lds
    s_add_u32 s9, s12, 12288
    buffer_load_dwordx4 a[32:35], v2, s[40:43], s9 offen
    buffer_load_dwordx4 a[36:39], v3, s[40:43], s9 offen
    s_waitcnt vmcnt(16)
    v_cvt_pk_bf16_f32 v24, v8, v9
    v_cvt_pk_bf16_f32 v25, v10, v11
    v_cvt_pk_bf16_f32 v26, v12, v13
    v_cvt_pk_bf16_f32 v27, v14, v15
    s_nop 1
    v_mfma_f32_32x32x16_bf16 a[64:79], v[24:27], a[40:43], 0
    v_mfma_f32_32x32x16_bf16 a[80:95], v[24:27], a[44:47], 0
    s_add_u32 s11, s56, 3456
    buffer_load_dwordx4 v[8:11], v7, s[40:43], s11 offen
    buffer_load_dwordx4 v[12:15], v7, s[40:43], s11 offen offset:16
    ds_read_b64_tr_b16 v[32:33], v5 offset:8192
    ds_read_b64_tr_b16 v[34:35], v5 offset:9216
    ds_read_b64_tr_b16 v[36:37], v6 offset:8192
    ds_read_b64_tr_b16 v[38:39], v6 offset:9216
    s_nop 4
    v_accvgpr_read_b32 v20, a72
    v_accvgpr_read_b32 v21, a88
    v_add_f32 v20, s57, v20
    v_add_f32 v21, s57, v21
    v_rcp_f32 v20, v20
    v_rcp_f32 v21, v21
    s_nop 0
    v_mul_f32 v20, v20, v16
    v_mul_f32 v21, v21, v17
    v_accvgpr_read_b32 v56, a64
    v_accvgpr_read_b32 v57, a65
    v_accvgpr_read_b32 v58, a66
    v_accvgpr_read_b32 v59, a67
    v_accvgpr_read_b32 v60, a68
    v_accvgpr_read_b32 v61, a69
    v_accvgpr_read_b32 v62, a70
    v_accvgpr_read_b32 v63, a71
    v_mul_f32 v56, v56, v20
    v_mul_f32 v57, v57, v20
    v_mul_f32 v58, v58, v20
    v_mul_f32 v59, v59, v20
    v_mul_f32 v60, v60, v20
    v_mul_f32 v61, v61, v20
    v_mul_f32 v62, v62, v20
    v_mul_f32 v63, v63, v20
    v_cvt_pk_bf16_f32 v48, v56, v57
    v_cvt_pk_bf16_f32 v49, v58, v59
    v_cvt_pk_bf16_f32 v50, v60, v61
    v_cvt_pk_bf16_f32 v51, v62, v63
    v_accvgpr_read_b32 v56, a80
    v_accvgpr_read_b32 v57, a81
    v_accvgpr_read_b32 v58, a82
    v_accvgpr_read_b32 v59, a83
    v_accvgpr_read_b32 v60, a84
    v_accvgpr_read_b32 v61, a85
    v_accvgpr_read_b32 v62, a86
    v_accvgpr_read_b32 v63, a87
    v_mul_f32 v56, v56, v21
    v_mul_f32 v57, v57, v21
    v_mul_f32 v58, v58, v21
    v_mul_f32 v59, v59, v21
    v_mul_f32 v60, v60, v21
    v_mul_f32 v61, v61, v21
    v_mul_f32 v62, v62, v21
    v_mul_f32 v63, v63, v21
    v_cvt_pk_bf16_f32 v52, v56, v57
    v_cvt_pk_bf16_f32 v53, v58, v59
    v_cvt_pk_bf16_f32 v54, v60, v61
    v_cvt_pk_bf16_f32 v55, v62, v63
    s_nop 1
    s_waitcnt lgkmcnt(4)
    v_mfma_f32_32x32x16_bf16 v[64:79], v[40:43], v[48:51], v[64:79]
    v_mfma_f32_32x32x16_bf16 v[80:95], v[40:43], v[52:55], v[80:95]
    v_mfma_f32_32x32x16_bf16 v[96:111], v[44:47], v[48:51], v[96:111]
    v_mfma_f32_32x32x16_bf16 v[112:127], v[44:47], v[52:55], v[112:127]
    s_add_u32 m0, s7, 6144
    s_add_u32 s10, s15, 65536
    buffer_load_dwordx4 v4, s[48:51], s10 offen lds
    s_add_u32 m0, s7, 7168
    s_add_u32 s10, s15, 73728
    buffer_load_dwordx4 v4, s[48:51], s10 offen lds
    s_add_u32 s9, s12, 13312
    buffer_load_dwordx4 a[40:43], v2, s[40:43], s9 offen
    buffer_load_dwordx4 a[44:47], v3, s[40:43], s9 offen
    s_waitcnt vmcnt(18)
    ds_read_b64_tr_b16 v[40:41], v5 offset:10240
    ds_read_b64_tr_b16 v[42:43], v5 offset:11264
    ds_read_b64_tr_b16 v[44:45], v6 offset:10240
    ds_read_b64_tr_b16 v[46:47], v6 offset:11264
    s_waitcnt lgkmcnt(4)
    v_mfma_f32_32x32x16_bf16 v[64:79], v[32:35], a[0:3], v[64:79]
    v_mfma_f32_32x32x16_bf16 v[80:95], v[32:35], a[4:7], v[80:95]
    v_mfma_f32_32x32x16_bf16 v[96:111], v[36:39], a[0:3], v[96:111]
    v_mfma_f32_32x32x16_bf16 v[112:127], v[36:39], a[4:7], v[112:127]
    s_add_u32 m0, s7, 8192
    s_add_u32 s10, s13, 245760
    buffer_load_dwordx4 v4, s[44:47], s10 offen lds
    s_add_u32 m0, s7, 9216
    s_add_u32 s10, s13, 253952
    buffer_load_dwordx4 v4, s[44:47], s10 offen lds
    s_add_u32 s9, s12, 14336
    buffer_load_dwordx4 a[0:3], v2, s[40:43], s9 offen
    buffer_load_dwordx4 a[4:7], v3, s[40:43], s9 offen
    s_waitcnt vmcnt(18)
    ds_read_b64_tr_b16 v[32:33], v5 offset:12288
    ds_read_b64_tr_b16 v[34:35], v5 offset:13312
    ds_read_b64_tr_b16 v[36:37], v6 offset:12288
    ds_read_b64_tr_b16 v[38:39], v6 offset:13312
    s_waitcnt lgkmcnt(4)
    v_mfma_f32_32x32x16_bf16 v[64:79], v[40:43], a[8:11], v[64:79]
    v_mfma_f32_32x32x16_bf16 v[80:95], v[40:43], a[12:15], v[80:95]
    v_mfma_f32_32x32x16_bf16 v[96:111], v[44:47], a[8:11], v[96:111]
    v_mfma_f32_32x32x16_bf16 v[112:127], v[44:47], a[12:15], v[112:127]
    s_add_u32 m0, s7, 10240
    s_add_u32 s10, s13, 262144
    buffer_load_dwordx4 v4, s[44:47], s10 offen lds
    s_add_u32 m0, s7, 11264
    s_add_u32 s10, s13, 270336
    buffer_load_dwordx4 v4, s[44:47], s10 offen lds
    s_add_u32 s9, s14, 4096
    buffer_load_dwordx4 a[8:11], v2, s[40:43], s9 offen
    buffer_load_dwordx4 a[12:15], v3, s[40:43], s9 offen
    s_waitcnt vmcnt(18)
    ds_read_b64_tr_b16 v[40:41], v5 offset:14336
    ds_read_b64_tr_b16 v[42:43], v5 offset:15360
    ds_read_b64_tr_b16 v[44:45], v6 offset:14336
    ds_read_b64_tr_b16 v[46:47], v6 offset:15360
    s_waitcnt lgkmcnt(4)
    v_mfma_f32_32x32x16_bf16 v[64:79], v[32:35], a[16:19], v[64:79]
    v_mfma_f32_32x32x16_bf16 v[80:95], v[32:35], a[20:23], v[80:95]
    v_mfma_f32_32x32x16_bf16 v[96:111], v[36:39], a[16:19], v[96:111]
    v_mfma_f32_32x32x16_bf16 v[112:127], v[36:39], a[20:23], v[112:127]
    s_add_u32 m0, s7, 12288
    s_add_u32 s10, s13, 278528
    buffer_load_dwordx4 v4, s[44:47], s10 offen lds
    s_add_u32 m0, s7, 13312
    s_add_u32 s10, s13, 286720
    buffer_load_dwordx4 v4, s[44:47], s10 offen lds
    s_add_u32 s9, s12, 15360
    buffer_load_dwordx4 a[16:19], v2, s[40:43], s9 offen
    buffer_load_dwordx4 a[20:23], v3, s[40:43], s9 offen
    s_waitcnt vmcnt(16)
    v_cvt_pk_bf16_f32 v24, v8, v9
    v_cvt_pk_bf16_f32 v25, v10, v11
    v_cvt_pk_bf16_f32 v26, v12, v13
    v_cvt_pk_bf16_f32 v27, v14, v15
    s_nop 1
    v_mfma_f32_32x32x16_bf16 a[64:79], v[24:27], a[24:27], 0
    v_mfma_f32_32x32x16_bf16 a[80:95], v[24:27], a[28:31], 0
    s_add_u32 s11, s56, 4608
    buffer_load_dwordx4 v[8:11], v7, s[40:43], s11 offen
    buffer_load_dwordx4 v[12:15], v7, s[40:43], s11 offen offset:16
    ds_read_b64_tr_b16 v[32:33], v5 offset:0
    ds_read_b64_tr_b16 v[34:35], v5 offset:1024
    ds_read_b64_tr_b16 v[36:37], v6 offset:0
    ds_read_b64_tr_b16 v[38:39], v6 offset:1024
    s_nop 4
    v_accvgpr_read_b32 v20, a72
    v_accvgpr_read_b32 v21, a88
    v_add_f32 v20, s57, v20
    v_add_f32 v21, s57, v21
    v_rcp_f32 v20, v20
    v_rcp_f32 v21, v21
    s_nop 0
    v_mul_f32 v20, v20, v16
    v_mul_f32 v21, v21, v17
    v_accvgpr_read_b32 v56, a64
    v_accvgpr_read_b32 v57, a65
    v_accvgpr_read_b32 v58, a66
    v_accvgpr_read_b32 v59, a67
    v_accvgpr_read_b32 v60, a68
    v_accvgpr_read_b32 v61, a69
    v_accvgpr_read_b32 v62, a70
    v_accvgpr_read_b32 v63, a71
    v_mul_f32 v56, v56, v20
    v_mul_f32 v57, v57, v20
    v_mul_f32 v58, v58, v20
    v_mul_f32 v59, v59, v20
    v_mul_f32 v60, v60, v20
    v_mul_f32 v61, v61, v20
    v_mul_f32 v62, v62, v20
    v_mul_f32 v63, v63, v20
    v_cvt_pk_bf16_f32 v48, v56, v57
    v_cvt_pk_bf16_f32 v49, v58, v59
    v_cvt_pk_bf16_f32 v50, v60, v61
    v_cvt_pk_bf16_f32 v51, v62, v63
    v_accvgpr_read_b32 v56, a80
    v_accvgpr_read_b32 v57, a81
    v_accvgpr_read_b32 v58, a82
    v_accvgpr_read_b32 v59, a83
    v_accvgpr_read_b32 v60, a84
    v_accvgpr_read_b32 v61, a85
    v_accvgpr_read_b32 v62, a86
    v_accvgpr_read_b32 v63, a87
    v_mul_f32 v56, v56, v21
    v_mul_f32 v57, v57, v21
    v_mul_f32 v58, v58, v21
    v_mul_f32 v59, v59, v21
    v_mul_f32 v60, v60, v21
    v_mul_f32 v61, v61, v21
    v_mul_f32 v62, v62, v21
    v_mul_f32 v63, v63, v21
    v_cvt_pk_bf16_f32 v52, v56, v57
    v_cvt_pk_bf16_f32 v53, v58, v59
    v_cvt_pk_bf16_f32 v54, v60, v61
    v_cvt_pk_bf16_f32 v55, v62, v63
    s_nop 1
    s_waitcnt lgkmcnt(4)
    v_mfma_f32_32x32x16_bf16 v[64:79], v[40:43], v[48:51], v[64:79]
    v_mfma_f32_32x32x16_bf16 v[80:95], v[40:43], v[52:55], v[80:95]
    v_mfma_f32_32x32x16_bf16 v[96:111], v[44:47], v[48:51], v[96:111]
    v_mfma_f32_32x32x16_bf16 v[112:127], v[44:47], v[52:55], v[112:127]
    s_add_u32 m0, s7, 14336
    s_add_u32 s10, s15, 81920
    buffer_load_dwordx4 v4, s[48:51], s10 offen lds
    s_add_u32 m0, s7, 15360
    s_add_u32 s10, s15, 90112
    buffer_load_dwordx4 v4, s[48:51], s10 offen lds
    s_add_u32 s9, s12, 16384
    buffer_load_dwordx4 a[24:27], v2, s[40:43], s9 offen
    buffer_load_dwordx4 a[28:31], v3, s[40:43], s9 offen
    s_waitcnt vmcnt(18)
    ds_read_b64_tr_b16 v[40:41], v5 offset:2048
    ds_read_b64_tr_b16 v[42:43], v5 offset:3072
    ds_read_b64_tr_b16 v[44:45], v6 offset:2048
    ds_read_b64_tr_b16 v[46:47], v6 offset:3072
    s_waitcnt lgkmcnt(4)
    v_mfma_f32_32x32x16_bf16 v[64:79], v[32:35], a[32:35], v[64:79]
    v_mfma_f32_32x32x16_bf16 v[80:95], v[32:35], a[36:39], v[80:95]
    v_mfma_f32_32x32x16_bf16 v[96:111], v[36:39], a[32:35], v[96:111]
    v_mfma_f32_32x32x16_bf16 v[112:127], v[36:39], a[36:39], v[112:127]
    s_add_u32 m0, s7, 0
    s_add_u32 s10, s13, 294912
    buffer_load_dwordx4 v4, s[44:47], s10 offen lds
    s_add_u32 m0, s7, 1024
    s_add_u32 s10, s13, 303104
    buffer_load_dwordx4 v4, s[44:47], s10 offen lds
    s_add_u32 s9, s12, 17408
    buffer_load_dwordx4 a[32:35], v2, s[40:43], s9 offen
    buffer_load_dwordx4 a[36:39], v3, s[40:43], s9 offen
    s_waitcnt vmcnt(18)
    ds_read_b64_tr_b16 v[32:33], v5 offset:4096
    ds_read_b64_tr_b16 v[34:35], v5 offset:5120
    ds_read_b64_tr_b16 v[36:37], v6 offset:4096
    ds_read_b64_tr_b16 v[38:39], v6 offset:5120
    s_waitcnt lgkmcnt(4)
    v_mfma_f32_32x32x16_bf16 v[64:79], v[40:43], a[40:43], v[64:79]
    v_mfma_f32_32x32x16_bf16 v[80:95], v[40:43], a[44:47], v[80:95]
    v_mfma_f32_32x32x16_bf16 v[96:111], v[44:47], a[40:43], v[96:111]
    v_mfma_f32_32x32x16_bf16 v[112:127], v[44:47], a[44:47], v[112:127]
    s_add_u32 m0, s7, 2048
    s_add_u32 s10, s13, 311296
    buffer_load_dwordx4 v4, s[44:47], s10 offen lds
    s_add_u32 m0, s7, 3072
    s_add_u32 s10, s13, 319488
    buffer_load_dwordx4 v4, s[44:47], s10 offen lds
    s_add_u32 s9, s14, 5120
    buffer_load_dwordx4 a[40:43], v2, s[40:43], s9 offen
    buffer_load_dwordx4 a[44:47], v3, s[40:43], s9 offen
    s_waitcnt vmcnt(18)
    ds_read_b64_tr_b16 v[40:41], v5 offset:6144
    ds_read_b64_tr_b16 v[42:43], v5 offset:7168
    ds_read_b64_tr_b16 v[44:45], v6 offset:6144
    ds_read_b64_tr_b16 v[46:47], v6 offset:7168
    s_waitcnt lgkmcnt(4)
    v_mfma_f32_32x32x16_bf16 v[64:79], v[32:35], a[0:3], v[64:79]
    v_mfma_f32_32x32x16_bf16 v[80:95], v[32:35], a[4:7], v[80:95]
    v_mfma_f32_32x32x16_bf16 v[96:111], v[36:39], a[0:3], v[96:111]
    v_mfma_f32_32x32x16_bf16 v[112:127], v[36:39], a[4:7], v[112:127]
    s_add_u32 m0, s7, 4096
    s_add_u32 s10, s13, 327680
    buffer_load_dwordx4 v4, s[44:47], s10 offen lds
    s_add_u32 m0, s7, 5120
    s_add_u32 s10, s13, 335872
    buffer_load_dwordx4 v4, s[44:47], s10 offen lds
    s_add_u32 s9, s12, 18432
    buffer_load_dwordx4 a[0:3], v2, s[40:43], s9 offen
    buffer_load_dwordx4 a[4:7], v3, s[40:43], s9 offen
    s_waitcnt vmcnt(16)
    v_cvt_pk_bf16_f32 v24, v8, v9
    v_cvt_pk_bf16_f32 v25, v10, v11
    v_cvt_pk_bf16_f32 v26, v12, v13
    v_cvt_pk_bf16_f32 v27, v14, v15
    s_nop 1
    v_mfma_f32_32x32x16_bf16 a[64:79], v[24:27], a[8:11], 0
    v_mfma_f32_32x32x16_bf16 a[80:95], v[24:27], a[12:15], 0
    s_add_u32 s11, s56, 5760
    buffer_load_dwordx4 v[8:11], v7, s[40:43], s11 offen
    buffer_load_dwordx4 v[12:15], v7, s[40:43], s11 offen offset:16
    ds_read_b64_tr_b16 v[32:33], v5 offset:8192
    ds_read_b64_tr_b16 v[34:35], v5 offset:9216
    ds_read_b64_tr_b16 v[36:37], v6 offset:8192
    ds_read_b64_tr_b16 v[38:39], v6 offset:9216
    s_nop 4
    v_accvgpr_read_b32 v20, a72
    v_accvgpr_read_b32 v21, a88
    v_add_f32 v20, s57, v20
    v_add_f32 v21, s57, v21
    v_rcp_f32 v20, v20
    v_rcp_f32 v21, v21
    s_nop 0
    v_mul_f32 v20, v20, v16
    v_mul_f32 v21, v21, v17
    v_accvgpr_read_b32 v56, a64
    v_accvgpr_read_b32 v57, a65
    v_accvgpr_read_b32 v58, a66
    v_accvgpr_read_b32 v59, a67
    v_accvgpr_read_b32 v60, a68
    v_accvgpr_read_b32 v61, a69
    v_accvgpr_read_b32 v62, a70
    v_accvgpr_read_b32 v63, a71
    v_mul_f32 v56, v56, v20
    v_mul_f32 v57, v57, v20
    v_mul_f32 v58, v58, v20
    v_mul_f32 v59, v59, v20
    v_mul_f32 v60, v60, v20
    v_mul_f32 v61, v61, v20
    v_mul_f32 v62, v62, v20
    v_mul_f32 v63, v63, v20
    v_cvt_pk_bf16_f32 v48, v56, v57
    v_cvt_pk_bf16_f32 v49, v58, v59
    v_cvt_pk_bf16_f32 v50, v60, v61
    v_cvt_pk_bf16_f32 v51, v62, v63
    v_accvgpr_read_b32 v56, a80
    v_accvgpr_read_b32 v57, a81
    v_accvgpr_read_b32 v58, a82
    v_accvgpr_read_b32 v59, a83
    v_accvgpr_read_b32 v60, a84
    v_accvgpr_read_b32 v61, a85
    v_accvgpr_read_b32 v62, a86
    v_accvgpr_read_b32 v63, a87
    v_mul_f32 v56, v56, v21
    v_mul_f32 v57, v57, v21
    v_mul_f32 v58, v58, v21
    v_mul_f32 v59, v59, v21
    v_mul_f32 v60, v60, v21
    v_mul_f32 v61, v61, v21
    v_mul_f32 v62, v62, v21
    v_mul_f32 v63, v63, v21
    v_cvt_pk_bf16_f32 v52, v56, v57
    v_cvt_pk_bf16_f32 v53, v58, v59
    v_cvt_pk_bf16_f32 v54, v60, v61
    v_cvt_pk_bf16_f32 v55, v62, v63
    s_nop 1
    s_waitcnt lgkmcnt(4)
    v_mfma_f32_32x32x16_bf16 v[64:79], v[40:43], v[48:51], v[64:79]
    v_mfma_f32_32x32x16_bf16 v[80:95], v[40:43], v[52:55], v[80:95]
    v_mfma_f32_32x32x16_bf16 v[96:111], v[44:47], v[48:51], v[96:111]
    v_mfma_f32_32x32x16_bf16 v[112:127], v[44:47], v[52:55], v[112:127]
    s_add_u32 m0, s7, 6144
    s_add_u32 s10, s15, 98304
    buffer_load_dwordx4 v4, s[48:51], s10 offen lds
    s_add_u32 m0, s7, 7168
    s_add_u32 s10, s15, 106496
    buffer_load_dwordx4 v4, s[48:51], s10 offen lds
    s_add_u32 s9, s12, 19456
    buffer_load_dwordx4 a[8:11], v2, s[40:43], s9 offen
    buffer_load_dwordx4 a[12:15], v3, s[40:43], s9 offen
    s_waitcnt vmcnt(18)
    ds_read_b64_tr_b16 v[40:41], v5 offset:10240
    ds_read_b64_tr_b16 v[42:43], v5 offset:11264
    ds_read_b64_tr_b16 v[44:45], v6 offset:10240
    ds_read_b64_tr_b16 v[46:47], v6 offset:11264
    s_waitcnt lgkmcnt(4)
    v_mfma_f32_32x32x16_bf16 v[64:79], v[32:35], a[16:19], v[64:79]
    v_mfma_f32_32x32x16_bf16 v[80:95], v[32:35], a[20:23], v[80:95]
    v_mfma_f32_32x32x16_bf16 v[96:111], v[36:39], a[16:19], v[96:111]
    v_mfma_f32_32x32x16_bf16 v[112:127], v[36:39], a[20:23], v[112:127]
    s_add_u32 m0, s7, 8192
    s_add_u32 s10, s13, 344064
    buffer_load_dwordx4 v4, s[44:47], s10 offen lds
    s_add_u32 m0, s7, 9216
    s_add_u32 s10, s13, 352256
    buffer_load_dwordx4 v4, s[44:47], s10 offen lds
    s_add_u32 s9, s12, 20480
    buffer_load_dwordx4 a[16:19], v2, s[40:43], s9 offen
    buffer_load_dwordx4 a[20:23], v3, s[40:43], s9 offen
    s_waitcnt vmcnt(18)
    ds_read_b64_tr_b16 v[32:33], v5 offset:12288
    ds_read_b64_tr_b16 v[34:35], v5 offset:13312
    ds_read_b64_tr_b16 v[36:37], v6 offset:12288
    ds_read_b64_tr_b16 v[38:39], v6 offset:13312
    s_waitcnt lgkmcnt(4)
    v_mfma_f32_32x32x16_bf16 v[64:79], v[40:43], a[24:27], v[64:79]
    v_mfma_f32_32x32x16_bf16 v[80:95], v[40:43], a[28:31], v[80:95]
    v_mfma_f32_32x32x16_bf16 v[96:111], v[44:47], a[24:27], v[96:111]
    v_mfma_f32_32x32x16_bf16 v[112:127], v[44:47], a[28:31], v[112:127]
    s_add_u32 m0, s7, 10240
    s_add_u32 s10, s13, 360448
    buffer_load_dwordx4 v4, s[44:47], s10 offen lds
    s_add_u32 m0, s7, 11264
    s_add_u32 s10, s13, 368640
    buffer_load_dwordx4 v4, s[44:47], s10 offen lds
    s_add_u32 s9, s14, 6144
    buffer_load_dwordx4 a[24:27], v2, s[40:43], s9 offen
    buffer_load_dwordx4 a[28:31], v3, s[40:43], s9 offen
    s_waitcnt vmcnt(18)
    ds_read_b64_tr_b16 v[40:41], v5 offset:14336
    ds_read_b64_tr_b16 v[42:43], v5 offset:15360
    ds_read_b64_tr_b16 v[44:45], v6 offset:14336
    ds_read_b64_tr_b16 v[46:47], v6 offset:15360
    s_waitcnt lgkmcnt(4)
    v_mfma_f32_32x32x16_bf16 v[64:79], v[32:35], a[32:35], v[64:79]
    v_mfma_f32_32x32x16_bf16 v[80:95], v[32:35], a[36:39], v[80:95]
    v_mfma_f32_32x32x16_bf16 v[96:111], v[36:39], a[32:35], v[96:111]
    v_mfma_f32_32x32x16_bf16 v[112:127], v[36:39], a[36:39], v[112:127]
    s_add_u32 m0, s7, 12288
    s_add_u32 s10, s13, 376832
    buffer_load_dwordx4 v4, s[44:47], s10 offen lds
    s_add_u32 m0, s7, 13312
    s_add_u32 s10, s13, 385024
    buffer_load_dwordx4 v4, s[44:47], s10 offen lds
    s_add_u32 s9, s12, 21504
    buffer_load_dwordx4 a[32:35], v2, s[40:43], s9 offen
    buffer_load_dwordx4 a[36:39], v3, s[40:43], s9 offen
    s_waitcnt vmcnt(16)
    v_cvt_pk_bf16_f32 v24, v8, v9
    v_cvt_pk_bf16_f32 v25, v10, v11
    v_cvt_pk_bf16_f32 v26, v12, v13
    v_cvt_pk_bf16_f32 v27, v14, v15
    s_nop 1
    v_mfma_f32_32x32x16_bf16 a[64:79], v[24:27], a[40:43], 0
    v_mfma_f32_32x32x16_bf16 a[80:95], v[24:27], a[44:47], 0
    s_add_u32 s11, s56, 6912
    buffer_load_dwordx4 v[8:11], v7, s[40:43], s11 offen
    buffer_load_dwordx4 v[12:15], v7, s[40:43], s11 offen offset:16
    ds_read_b64_tr_b16 v[32:33], v5 offset:0
    ds_read_b64_tr_b16 v[34:35], v5 offset:1024
    ds_read_b64_tr_b16 v[36:37], v6 offset:0
    ds_read_b64_tr_b16 v[38:39], v6 offset:1024
    s_nop 4
    v_accvgpr_read_b32 v20, a72
    v_accvgpr_read_b32 v21, a88
    v_add_f32 v20, s57, v20
    v_add_f32 v21, s57, v21
    v_rcp_f32 v20, v20
    v_rcp_f32 v21, v21
    s_nop 0
    v_mul_f32 v20, v20, v16
    v_mul_f32 v21, v21, v17
    v_accvgpr_read_b32 v56, a64
    v_accvgpr_read_b32 v57, a65
    v_accvgpr_read_b32 v58, a66
    v_accvgpr_read_b32 v59, a67
    v_accvgpr_read_b32 v60, a68
    v_accvgpr_read_b32 v61, a69
    v_accvgpr_read_b32 v62, a70
    v_accvgpr_read_b32 v63, a71
    v_mul_f32 v56, v56, v20
    v_mul_f32 v57, v57, v20
    v_mul_f32 v58, v58, v20
    v_mul_f32 v59, v59, v20
    v_mul_f32 v60, v60, v20
    v_mul_f32 v61, v61, v20
    v_mul_f32 v62, v62, v20
    v_mul_f32 v63, v63, v20
    v_cvt_pk_bf16_f32 v48, v56, v57
    v_cvt_pk_bf16_f32 v49, v58, v59
    v_cvt_pk_bf16_f32 v50, v60, v61
    v_cvt_pk_bf16_f32 v51, v62, v63
    v_accvgpr_read_b32 v56, a80
    v_accvgpr_read_b32 v57, a81
    v_accvgpr_read_b32 v58, a82
    v_accvgpr_read_b32 v59, a83
    v_accvgpr_read_b32 v60, a84
    v_accvgpr_read_b32 v61, a85
    v_accvgpr_read_b32 v62, a86
    v_accvgpr_read_b32 v63, a87
    v_mul_f32 v56, v56, v21
    v_mul_f32 v57, v57, v21
    v_mul_f32 v58, v58, v21
    v_mul_f32 v59, v59, v21
    v_mul_f32 v60, v60, v21
    v_mul_f32 v61, v61, v21
    v_mul_f32 v62, v62, v21
    v_mul_f32 v63, v63, v21
    v_cvt_pk_bf16_f32 v52, v56, v57
    v_cvt_pk_bf16_f32 v53, v58, v59
    v_cvt_pk_bf16_f32 v54, v60, v61
    v_cvt_pk_bf16_f32 v55, v62, v63
    s_nop 1
    s_waitcnt lgkmcnt(4)
    v_mfma_f32_32x32x16_bf16 v[64:79], v[40:43], v[48:51], v[64:79]
    v_mfma_f32_32x32x16_bf16 v[80:95], v[40:43], v[52:55], v[80:95]
    v_mfma_f32_32x32x16_bf16 v[96:111], v[44:47], v[48:51], v[96:111]
    v_mfma_f32_32x32x16_bf16 v[112:127], v[44:47], v[52:55], v[112:127]
    s_add_u32 m0, s7, 14336
    s_add_u32 s10, s15, 114688
    buffer_load_dwordx4 v4, s[48:51], s10 offen lds
    s_add_u32 m0, s7, 15360
    s_add_u32 s10, s15, 122880
    buffer_load_dwordx4 v4, s[48:51], s10 offen lds
    s_add_u32 s9, s12, 22528
    buffer_load_dwordx4 a[40:43], v2, s[40:43], s9 offen
    buffer_load_dwordx4 a[44:47], v3, s[40:43], s9 offen
    s_waitcnt vmcnt(18)
    ds_read_b64_tr_b16 v[40:41], v5 offset:2048
    ds_read_b64_tr_b16 v[42:43], v5 offset:3072
    ds_read_b64_tr_b16 v[44:45], v6 offset:2048
    ds_read_b64_tr_b16 v[46:47], v6 offset:3072
    s_waitcnt lgkmcnt(4)
    v_mfma_f32_32x32x16_bf16 v[64:79], v[32:35], a[0:3], v[64:79]
    v_mfma_f32_32x32x16_bf16 v[80:95], v[32:35], a[4:7], v[80:95]
    v_mfma_f32_32x32x16_bf16 v[96:111], v[36:39], a[0:3], v[96:111]
    v_mfma_f32_32x32x16_bf16 v[112:127], v[36:39], a[4:7], v[112:127]
    s_add_u32 m0, s7, 0
    s_add_u32 s10, s13, 393216
    buffer_load_dwordx4 v4, s[44:47], s10 offen lds
    s_add_u32 m0, s7, 1024
    s_add_u32 s10, s13, 401408
    buffer_load_dwordx4 v4, s[44:47], s10 offen lds
    s_add_u32 s9, s12, 23552
    buffer_load_dwordx4 a[0:3], v2, s[40:43], s9 offen
    buffer_load_dwordx4 a[4:7], v3, s[40:43], s9 offen
    s_waitcnt vmcnt(18)
    ds_read_b64_tr_b16 v[32:33], v5 offset:4096
    ds_read_b64_tr_b16 v[34:35], v5 offset:5120
    ds_read_b64_tr_b16 v[36:37], v6 offset:4096
    ds_read_b64_tr_b16 v[38:39], v6 offset:5120
    s_waitcnt lgkmcnt(4)
    v_mfma_f32_32x32x16_bf16 v[64:79], v[40:43], a[8:11], v[64:79]
    v_mfma_f32_32x32x16_bf16 v[80:95], v[40:43], a[12:15], v[80:95]
    v_mfma_f32_32x32x16_bf16 v[96:111], v[44:47], a[8:11], v[96:111]
    v_mfma_f32_32x32x16_bf16 v[112:127], v[44:47], a[12:15], v[112:127]
    s_add_u32 m0, s7, 2048
    s_add_u32 s10, s13, 409600
    buffer_load_dwordx4 v4, s[44:47], s10 offen lds
    s_add_u32 m0, s7, 3072
    s_add_u32 s10, s13, 417792
    buffer_load_dwordx4 v4, s[44:47], s10 offen lds
    s_add_u32 s9, s14, 7168
    buffer_load_dwordx4 a[8:11], v2, s[40:43], s9 offen
    buffer_load_dwordx4 a[12:15], v3, s[40:43], s9 offen
    s_waitcnt vmcnt(18)
    ds_read_b64_tr_b16 v[40:41], v5 offset:6144
    ds_read_b64_tr_b16 v[42:43], v5 offset:7168
    ds_read_b64_tr_b16 v[44:45], v6 offset:6144
    ds_read_b64_tr_b16 v[46:47], v6 offset:7168
    s_waitcnt lgkmcnt(4)
    v_mfma_f32_32x32x16_bf16 v[64:79], v[32:35], a[16:19], v[64:79]
    v_mfma_f32_32x32x16_bf16 v[80:95], v[32:35], a[20:23], v[80:95]
    v_mfma_f32_32x32x16_bf16 v[96:111], v[36:39], a[16:19], v[96:111]
    v_mfma_f32_32x32x16_bf16 v[112:127], v[36:39], a[20:23], v[112:127]
    s_add_u32 m0, s7, 4096
    s_add_u32 s10, s13, 425984
    buffer_load_dwordx4 v4, s[44:47], s10 offen lds
    s_add_u32 m0, s7, 5120
    s_add_u32 s10, s13, 434176
    buffer_load_dwordx4 v4, s[44:47], s10 offen lds
    s_add_u32 s9, s12, 24576
    buffer_load_dwordx4 a[16:19], v2, s[40:43], s9 offen
    buffer_load_dwordx4 a[20:23], v3, s[40:43], s9 offen
    s_waitcnt vmcnt(16)
    v_cvt_pk_bf16_f32 v24, v8, v9
    v_cvt_pk_bf16_f32 v25, v10, v11
    v_cvt_pk_bf16_f32 v26, v12, v13
    v_cvt_pk_bf16_f32 v27, v14, v15
    s_nop 1
    v_mfma_f32_32x32x16_bf16 a[64:79], v[24:27], a[24:27], 0
    v_mfma_f32_32x32x16_bf16 a[80:95], v[24:27], a[28:31], 0
    s_add_u32 s11, s56, 8064
    buffer_load_dwordx4 v[8:11], v7, s[40:43], s11 offen
    buffer_load_dwordx4 v[12:15], v7, s[40:43], s11 offen offset:16
    ds_read_b64_tr_b16 v[32:33], v5 offset:8192
    ds_read_b64_tr_b16 v[34:35], v5 offset:9216
    ds_read_b64_tr_b16 v[36:37], v6 offset:8192
    ds_read_b64_tr_b16 v[38:39], v6 offset:9216
    s_nop 4
    v_accvgpr_read_b32 v20, a72
    v_accvgpr_read_b32 v21, a88
    v_add_f32 v20, s57, v20
    v_add_f32 v21, s57, v21
    v_rcp_f32 v20, v20
    v_rcp_f32 v21, v21
    s_nop 0
    v_mul_f32 v20, v20, v16
    v_mul_f32 v21, v21, v17
    v_accvgpr_read_b32 v56, a64
    v_accvgpr_read_b32 v57, a65
    v_accvgpr_read_b32 v58, a66
    v_accvgpr_read_b32 v59, a67
    v_accvgpr_read_b32 v60, a68
    v_accvgpr_read_b32 v61, a69
    v_accvgpr_read_b32 v62, a70
    v_accvgpr_read_b32 v63, a71
    v_mul_f32 v56, v56, v20
    v_mul_f32 v57, v57, v20
    v_mul_f32 v58, v58, v20
    v_mul_f32 v59, v59, v20
    v_mul_f32 v60, v60, v20
    v_mul_f32 v61, v61, v20
    v_mul_f32 v62, v62, v20
    v_mul_f32 v63, v63, v20
    v_cvt_pk_bf16_f32 v48, v56, v57
    v_cvt_pk_bf16_f32 v49, v58, v59
    v_cvt_pk_bf16_f32 v50, v60, v61
    v_cvt_pk_bf16_f32 v51, v62, v63
    v_accvgpr_read_b32 v56, a80
    v_accvgpr_read_b32 v57, a81
    v_accvgpr_read_b32 v58, a82
    v_accvgpr_read_b32 v59, a83
    v_accvgpr_read_b32 v60, a84
    v_accvgpr_read_b32 v61, a85
    v_accvgpr_read_b32 v62, a86
    v_accvgpr_read_b32 v63, a87
    v_mul_f32 v56, v56, v21
    v_mul_f32 v57, v57, v21
    v_mul_f32 v58, v58, v21
    v_mul_f32 v59, v59, v21
    v_mul_f32 v60, v60, v21
    v_mul_f32 v61, v61, v21
    v_mul_f32 v62, v62, v21
    v_mul_f32 v63, v63, v21
    v_cvt_pk_bf16_f32 v52, v56, v57
    v_cvt_pk_bf16_f32 v53, v58, v59
    v_cvt_pk_bf16_f32 v54, v60, v61
    v_cvt_pk_bf16_f32 v55, v62, v63
    s_nop 1
    s_waitcnt lgkmcnt(4)
    v_mfma_f32_32x32x16_bf16 v[64:79], v[40:43], v[48:51], v[64:79]
    v_mfma_f32_32x32x16_bf16 v[80:95], v[40:43], v[52:55], v[80:95]
    v_mfma_f32_32x32x16_bf16 v[96:111], v[44:47], v[48:51], v[96:111]
    v_mfma_f32_32x32x16_bf16 v[112:127], v[44:47], v[52:55], v[112:127]
    s_add_u32 m0, s7, 6144
    s_add_u32 s10, s13, 442368
    buffer_load_dwordx4 v4, s[44:47], s10 offen lds
    s_add_u32 m0, s7, 7168
    s_add_u32 s10, s13, 450560
    buffer_load_dwordx4 v4, s[44:47], s10 offen lds
    s_add_u32 s9, s12, 25600
    buffer_load_dwordx4 a[24:27], v2, s[40:43], s9 offen
    buffer_load_dwordx4 a[28:31], v3, s[40:43], s9 offen
    s_waitcnt vmcnt(18)
    ds_read_b64_tr_b16 v[40:41], v5 offset:10240
    ds_read_b64_tr_b16 v[42:43], v5 offset:11264
    ds_read_b64_tr_b16 v[44:45], v6 offset:10240
    ds_read_b64_tr_b16 v[46:47], v6 offset:11264
    s_waitcnt lgkmcnt(4)
    v_mfma_f32_32x32x16_bf16 v[64:79], v[32:35], a[32:35], v[64:79]
    v_mfma_f32_32x32x16_bf16 v[80:95], v[32:35], a[36:39], v[80:95]
    v_mfma_f32_32x32x16_bf16 v[96:111], v[36:39], a[32:35], v[96:111]
    v_mfma_f32_32x32x16_bf16 v[112:127], v[36:39], a[36:39], v[112:127]
    s_add_u32 s9, s12, 26624
    buffer_load_dwordx4 a[32:35], v2, s[40:43], s9 offen
    buffer_load_dwordx4 a[36:39], v3, s[40:43], s9 offen
    s_waitcnt vmcnt(16)
    ds_read_b64_tr_b16 v[32:33], v5 offset:12288
    ds_read_b64_tr_b16 v[34:35], v5 offset:13312
    ds_read_b64_tr_b16 v[36:37], v6 offset:12288
    ds_read_b64_tr_b16 v[38:39], v6 offset:13312
    s_waitcnt lgkmcnt(4)
    v_mfma_f32_32x32x16_bf16 v[64:79], v[40:43], a[40:43], v[64:79]
    v_mfma_f32_32x32x16_bf16 v[80:95], v[40:43], a[44:47], v[80:95]
    v_mfma_f32_32x32x16_bf16 v[96:111], v[44:47], a[40:43], v[96:111]
    v_mfma_f32_32x32x16_bf16 v[112:127], v[44:47], a[44:47], v[112:127]
    s_add_u32 s9, s12, 27648
    buffer_load_dwordx4 a[40:43], v2, s[40:43], s9 offen
    buffer_load_dwordx4 a[44:47], v3, s[40:43], s9 offen
    s_waitcnt vmcnt(14)
    ds_read_b64_tr_b16 v[40:41], v5 offset:14336
    ds_read_b64_tr_b16 v[42:43], v5 offset:15360
    ds_read_b64_tr_b16 v[44:45], v6 offset:14336
    ds_read_b64_tr_b16 v[46:47], v6 offset:15360
    s_waitcnt lgkmcnt(4)
    v_mfma_f32_32x32x16_bf16 v[64:79], v[32:35], a[0:3], v[64:79]
    v_mfma_f32_32x32x16_bf16 v[80:95], v[32:35], a[4:7], v[80:95]
    v_mfma_f32_32x32x16_bf16 v[96:111], v[36:39], a[0:3], v[96:111]
    v_mfma_f32_32x32x16_bf16 v[112:127], v[36:39], a[4:7], v[112:127]
    s_waitcnt vmcnt(8)
    v_cvt_pk_bf16_f32 v24, v8, v9
    v_cvt_pk_bf16_f32 v25, v10, v11
    v_cvt_pk_bf16_f32 v26, v12, v13
    v_cvt_pk_bf16_f32 v27, v14, v15
    s_nop 1
    v_mfma_f32_32x32x16_bf16 a[64:79], v[24:27], a[8:11], 0
    v_mfma_f32_32x32x16_bf16 a[80:95], v[24:27], a[12:15], 0
    ds_read_b64_tr_b16 v[32:33], v5 offset:0
    ds_read_b64_tr_b16 v[34:35], v5 offset:1024
    ds_read_b64_tr_b16 v[36:37], v6 offset:0
    ds_read_b64_tr_b16 v[38:39], v6 offset:1024
    s_nop 7
    v_accvgpr_read_b32 v20, a72
    v_accvgpr_read_b32 v21, a88
    v_add_f32 v20, s57, v20
    v_add_f32 v21, s57, v21
    v_rcp_f32 v20, v20
    v_rcp_f32 v21, v21
    s_nop 0
    v_mul_f32 v20, v20, v16
    v_mul_f32 v21, v21, v17
    v_accvgpr_read_b32 v56, a64
    v_accvgpr_read_b32 v57, a65
    v_accvgpr_read_b32 v58, a66
    v_accvgpr_read_b32 v59, a67
    v_accvgpr_read_b32 v60, a68
    v_accvgpr_read_b32 v61, a69
    v_accvgpr_read_b32 v62, a70
    v_accvgpr_read_b32 v63, a71
    v_mul_f32 v56, v56, v20
    v_mul_f32 v57, v57, v20
    v_mul_f32 v58, v58, v20
    v_mul_f32 v59, v59, v20
    v_mul_f32 v60, v60, v20
    v_mul_f32 v61, v61, v20
    v_mul_f32 v62, v62, v20
    v_mul_f32 v63, v63, v20
    v_cvt_pk_bf16_f32 v48, v56, v57
    v_cvt_pk_bf16_f32 v49, v58, v59
    v_cvt_pk_bf16_f32 v50, v60, v61
    v_cvt_pk_bf16_f32 v51, v62, v63
    v_accvgpr_read_b32 v56, a80
    v_accvgpr_read_b32 v57, a81
    v_accvgpr_read_b32 v58, a82
    v_accvgpr_read_b32 v59, a83
    v_accvgpr_read_b32 v60, a84
    v_accvgpr_read_b32 v61, a85
    v_accvgpr_read_b32 v62, a86
    v_accvgpr_read_b32 v63, a87
    v_mul_f32 v56, v56, v21
    v_mul_f32 v57, v57, v21
    v_mul_f32 v58, v58, v21
    v_mul_f32 v59, v59, v21
    v_mul_f32 v60, v60, v21
    v_mul_f32 v61, v61, v21
    v_mul_f32 v62, v62, v21
    v_mul_f32 v63, v63, v21
    v_cvt_pk_bf16_f32 v52, v56, v57
    v_cvt_pk_bf16_f32 v53, v58, v59
    v_cvt_pk_bf16_f32 v54, v60, v61
    v_cvt_pk_bf16_f32 v55, v62, v63
    s_nop 1
    s_waitcnt lgkmcnt(4)
    v_mfma_f32_32x32x16_bf16 v[64:79], v[40:43], v[48:51], v[64:79]
    v_mfma_f32_32x32x16_bf16 v[80:95], v[40:43], v[52:55], v[80:95]
    v_mfma_f32_32x32x16_bf16 v[96:111], v[44:47], v[48:51], v[96:111]
    v_mfma_f32_32x32x16_bf16 v[112:127], v[44:47], v[52:55], v[112:127]
    s_waitcnt vmcnt(4)
    ds_read_b64_tr_b16 v[40:41], v5 offset:2048
    ds_read_b64_tr_b16 v[42:43], v5 offset:3072
    ds_read_b64_tr_b16 v[44:45], v6 offset:2048
    ds_read_b64_tr_b16 v[46:47], v6 offset:3072
    s_waitcnt lgkmcnt(4)
    v_mfma_f32_32x32x16_bf16 v[64:79], v[32:35], a[16:19], v[64:79]
    v_mfma_f32_32x32x16_bf16 v[80:95], v[32:35], a[20:23], v[80:95]
    v_mfma_f32_32x32x16_bf16 v[96:111], v[36:39], a[16:19], v[96:111]
    v_mfma_f32_32x32x16_bf16 v[112:127], v[36:39], a[20:23], v[112:127]
    s_waitcnt vmcnt(2)
    ds_read_b64_tr_b16 v[32:33], v5 offset:4096
    ds_read_b64_tr_b16 v[34:35], v5 offset:5120
    ds_read_b64_tr_b16 v[36:37], v6 offset:4096
    ds_read_b64_tr_b16 v[38:39], v6 offset:5120
    s_waitcnt lgkmcnt(4)
    v_mfma_f32_32x32x16_bf16 v[64:79], v[40:43], a[24:27], v[64:79]
    v_mfma_f32_32x32x16_bf16 v[80:95], v[40:43], a[28:31], v[80:95]
    v_mfma_f32_32x32x16_bf16 v[96:111], v[44:47], a[24:27], v[96:111]
    v_mfma_f32_32x32x16_bf16 v[112:127], v[44:47], a[28:31], v[112:127]
    s_waitcnt vmcnt(0)
    ds_read_b64_tr_b16 v[40:41], v5 offset:6144
    ds_read_b64_tr_b16 v[42:43], v5 offset:7168
    ds_read_b64_tr_b16 v[44:45], v6 offset:6144
    ds_read_b64_tr_b16 v[46:47], v6 offset:7168
    s_waitcnt lgkmcnt(4)
    v_mfma_f32_32x32x16_bf16 v[64:79], v[32:35], a[32:35], v[64:79]
    v_mfma_f32_32x32x16_bf16 v[80:95], v[32:35], a[36:39], v[80:95]
    v_mfma_f32_32x32x16_bf16 v[96:111], v[36:39], a[32:35], v[96:111]
    v_mfma_f32_32x32x16_bf16 v[112:127], v[36:39], a[36:39], v[112:127]
    s_waitcnt lgkmcnt(0)
    v_mfma_f32_32x32x16_bf16 v[64:79], v[40:43], a[40:43], v[64:79]
    v_mfma_f32_32x32x16_bf16 v[80:95], v[40:43], a[44:47], v[80:95]
    v_mfma_f32_32x32x16_bf16 v[96:111], v[44:47], a[40:43], v[96:111]
    v_mfma_f32_32x32x16_bf16 v[112:127], v[44:47], a[44:47], v[112:127]
    v_lshrrev_b32 v9, 3, v1
    s_mul_i32 s8, s4, 16
    v_add_u32 v9, s8, v9
    v_lshlrev_b32 v13, 3, v9
    s_lshl_b32 s8, s5, 9
    s_add_u32 s8, s8, 9474052
    buffer_load_dword v20, v13, s[40:43], s8 offen offset:0
    buffer_load_dword v21, v13, s[40:43], s8 offen offset:64
    v_and_b32 v8, 31, v1
    v_lshrrev_b32 v10, 5, v1
    v_mul_u32_u24 v8, 272, v8
    v_lshl_add_u32 v8, v10, 4, v8
    s_mul_i32 s8, s4, 17408
    v_add_u32 v8, s8, v8
    v_and_b32 v10, 7, v1
    v_mul_u32_u24 v11, 272, v9
    v_lshl_add_u32 v11, v10, 5, v11
    v_add_u32 v14, 52224, v11
    v_add_u32 v15, 104448, v11
    v_lshlrev_b32 v12, 10, v9
    v_lshl_add_u32 v12, v10, 4, v12
    s_lshl_b32 s8, s5, 16
    s_lshl_b32 s9, s6, 7
    s_add_u32 s8, s8, s9
    ds_write_b128 v8, v[64:67] offset:0
    ds_write_b128 v8, v[68:71] offset:32
    ds_write_b128 v8, v[72:75] offset:64
    ds_write_b128 v8, v[76:79] offset:96
    ds_write_b128 v8, v[80:83] offset:8704
    ds_write_b128 v8, v[84:87] offset:8736
    ds_write_b128 v8, v[88:91] offset:8768
    ds_write_b128 v8, v[92:95] offset:8800
    ds_write_b128 v8, v[96:99] offset:128
    ds_write_b128 v8, v[100:103] offset:160
    ds_write_b128 v8, v[104:107] offset:192
    ds_write_b128 v8, v[108:111] offset:224
    ds_write_b128 v8, v[112:115] offset:8832
    ds_write_b128 v8, v[116:119] offset:8864
    ds_write_b128 v8, v[120:123] offset:8896
    ds_write_b128 v8, v[124:127] offset:8928
    s_waitcnt lgkmcnt(0)
    s_barrier
    ds_read_b128 v[64:67], v11 offset:0
    ds_read_b128 v[68:71], v11 offset:16
    ds_read_b128 v[72:75], v11 offset:17408
    ds_read_b128 v[76:79], v11 offset:17424
    ds_read_b128 v[80:83], v11 offset:34816
    ds_read_b128 v[84:87], v11 offset:34832
    ds_read_b128 v[88:91], v14 offset:0
    ds_read_b128 v[92:95], v14 offset:16
    ds_read_b128 v[96:99], v11 offset:2176
    ds_read_b128 v[100:103], v11 offset:2192
    ds_read_b128 v[104:107], v11 offset:19584
    ds_read_b128 v[108:111], v11 offset:19600
    ds_read_b128 v[112:115], v11 offset:36992
    ds_read_b128 v[116:119], v11 offset:37008
    ds_read_b128 v[120:123], v14 offset:2176
    ds_read_b128 v[124:127], v14 offset:2192
    s_waitcnt lgkmcnt(0) vmcnt(0)
    v_add_f32 v64, v64, v72
    v_add_f32 v65, v65, v73
    v_add_f32 v66, v66, v74
    v_add_f32 v67, v67, v75
    v_add_f32 v68, v68, v76
    v_add_f32 v69, v69, v77
    v_add_f32 v70, v70, v78
    v_add_f32 v71, v71, v79
    v_add_f32 v80, v80, v88
    v_add_f32 v81, v81, v89
    v_add_f32 v82, v82, v90
    v_add_f32 v83, v83, v91
    v_add_f32 v84, v84, v92
    v_add_f32 v85, v85, v93
    v_add_f32 v86, v86, v94
    v_add_f32 v87, v87, v95
    v_add_f32 v64, v64, v80
    v_add_f32 v65, v65, v81
    v_add_f32 v66, v66, v82
    v_add_f32 v67, v67, v83
    v_add_f32 v68, v68, v84
    v_add_f32 v69, v69, v85
    v_add_f32 v70, v70, v86
    v_add_f32 v71, v71, v87
    v_mul_f32 v64, v64, v20
    v_mul_f32 v65, v65, v20
    v_mul_f32 v66, v66, v20
    v_mul_f32 v67, v67, v20
    v_mul_f32 v68, v68, v20
    v_mul_f32 v69, v69, v20
    v_mul_f32 v70, v70, v20
    v_mul_f32 v71, v71, v20
    v_cvt_pk_bf16_f32 v72, v64, v65
    v_cvt_pk_bf16_f32 v73, v66, v67
    v_cvt_pk_bf16_f32 v74, v68, v69
    v_cvt_pk_bf16_f32 v75, v70, v71
    buffer_store_dwordx4 v[72:75], v12, s[52:55], s8 offen sc0 sc1
    v_add_f32 v96, v96, v104
    v_add_f32 v97, v97, v105
    v_add_f32 v98, v98, v106
    v_add_f32 v99, v99, v107
    v_add_f32 v100, v100, v108
    v_add_f32 v101, v101, v109
    v_add_f32 v102, v102, v110
    v_add_f32 v103, v103, v111
    v_add_f32 v112, v112, v120
    v_add_f32 v113, v113, v121
    v_add_f32 v114, v114, v122
    v_add_f32 v115, v115, v123
    v_add_f32 v116, v116, v124
    v_add_f32 v117, v117, v125
    v_add_f32 v118, v118, v126
    v_add_f32 v119, v119, v127
    v_add_f32 v96, v96, v112
    v_add_f32 v97, v97, v113
    v_add_f32 v98, v98, v114
    v_add_f32 v99, v99, v115
    v_add_f32 v100, v100, v116
    v_add_f32 v101, v101, v117
    v_add_f32 v102, v102, v118
    v_add_f32 v103, v103, v119
    v_mul_f32 v96, v96, v21
    v_mul_f32 v97, v97, v21
    v_mul_f32 v98, v98, v21
    v_mul_f32 v99, v99, v21
    v_mul_f32 v100, v100, v21
    v_mul_f32 v101, v101, v21
    v_mul_f32 v102, v102, v21
    v_mul_f32 v103, v103, v21
    v_cvt_pk_bf16_f32 v104, v96, v97
    v_cvt_pk_bf16_f32 v105, v98, v99
    v_cvt_pk_bf16_f32 v106, v100, v101
    v_cvt_pk_bf16_f32 v107, v102, v103
    s_add_u32 s8, s8, 8192
    buffer_store_dwordx4 v[104:107], v12, s[52:55], s8 offen sc0 sc1
K2_done:
    s_endpgm
.p2align 8
CODE_END:
    s_endpgm
.section .rodata,"a"
.p2align 6
.amdhsa_kernel k1_kernel
  .amdhsa_next_free_vgpr 256
  .amdhsa_next_free_sgpr 102
  .amdhsa_accum_offset 128
  .amdhsa_group_segment_fixed_size 0
  .amdhsa_kernarg_size 88
  .amdhsa_user_sgpr_count 2
  .amdhsa_user_sgpr_kernarg_segment_ptr 1
  .amdhsa_system_sgpr_workgroup_id_x 1
  .amdhsa_float_denorm_mode_32 3
.end_amdhsa_kernel
.p2align 6
.amdhsa_kernel k2_kernel
  .amdhsa_next_free_vgpr 224
  .amdhsa_next_free_sgpr 102
  .amdhsa_accum_offset 128
  .amdhsa_group_segment_fixed_size 0
  .amdhsa_kernarg_size 88
  .amdhsa_user_sgpr_count 2
  .amdhsa_user_sgpr_kernarg_segment_ptr 1
  .amdhsa_system_sgpr_workgroup_id_x 1
  .amdhsa_float_denorm_mode_32 3
.end_amdhsa_kernel
```
